```python
import torch

def _softmax(x, axis=-1):
    return torch.softmax(x, dim=axis)
def _gelu(x):
    return torch.nn.functional.gelu(x, approximate="tanh")
def _silu(x):
    return torch.nn.functional.silu(x)
def _sigmoid(x):
    return torch.sigmoid(x)
def _layernorm(x, axis=-1, eps=1e-5):
    m = x.mean(dim=axis, keepdim=True)
    v = x.var(dim=axis, keepdim=True, unbiased=False)
    return (x - m) / torch.sqrt(v + eps)
def _scatter_add(tgt, idx, src, axis=0):
    return tgt.clone().index_add_(axis, idx, src)
def _segment_sum(src, seg, n):
    out = torch.zeros((n,) + src.shape[1:], dtype=src.dtype)
    return out.index_add_(0, seg, src)
def _pad(x, pw):
    flat = tuple(v for pair in reversed(pw) for v in pair)
    return torch.nn.functional.pad(x, flat)

kernel_name = 'standalone__deep_cross_xdeepfm__recsys'

def setup_inputs():

    _w = (lambda a: (lambda t: t.to(torch.bfloat16) if t.is_floating_point() else t)(torch.as_tensor(a)))
    B, F, D, L = 1024, 26, 32, 3
    V = min(100000, 100000)
    Din = F * D
    return {
        "idx": _w((lambda lo, hi, *s: torch.randint(lo, hi, s))(0, V, B, F).to(torch.int64)),
        "table": _w((lambda *s: torch.randn(*s, dtype=torch.bfloat16) * 1.6)(V, D)),
        "ws_cin": _w((lambda *s: torch.randn(*s, dtype=torch.bfloat16) * 0.1)(L, F, F, F) * (1.0 / F)),
        "w_cin_out": _w((lambda *s: torch.randn(*s, dtype=torch.bfloat16) * 0.1)(L * F) * ((L * F) ** -0.5)),
        "w_dnn1": _w((lambda *s: torch.randn(*s, dtype=torch.bfloat16) * 1.6)(Din, Din) * (Din ** -0.5)),
        "b_dnn1": _w((lambda *s: torch.randn(*s, dtype=torch.bfloat16) * 12.8)(Din) * 0.1),
        "w_dnn2": _w((lambda *s: torch.randn(*s, dtype=torch.bfloat16) * 0.05)(Din) * (Din ** -0.5)),
        "b_out": _w((lambda *s: torch.randn(*s, dtype=torch.bfloat16) * 1.6)(1)),
    }

def reference(idx, table, ws_cin, w_cin_out, w_dnn1, b_dnn1, w_dnn2, b_out):
    x0 = table[idx]
    B = x0.shape[0]
    L = ws_cin.shape[0]
    xk = x0
    pooled = []
    for l in range(L):
        xk = torch.einsum('bid,bjd,hij->bhd', xk, x0, ws_cin[l])
        pooled.append(xk.sum(axis=-1))
    p_plus = torch.stack(pooled, axis=1).reshape(B, -1)
    logit_cin = p_plus @ w_cin_out
    h = x0.reshape(B, -1)
    h = _gelu(h @ w_dnn1 + b_dnn1)
    logit_dnn = h @ w_dnn2
    return logit_cin + logit_dnn + b_out
```

```asm
; @launch grid=(256,1,1) block=(512,1,1) lds=156736
.amdgcn_target "amdgcn-amd-amdhsa--gfx950"
.text
.globl standalone__deep_cross_xdeepfm__recsys_kernel
.p2align 8
.type standalone__deep_cross_xdeepfm__recsys_kernel,@function
standalone__deep_cross_xdeepfm__recsys_kernel:
    s_cmp_ge_u32 s2, 256
    s_cbranch_scc1 L_end
    s_load_dwordx16 s[4:19], s[0:1], 0
    s_load_dwordx4 s[20:23], s[0:1], 64
    s_load_dwordx2 s[24:25], s[0:1], 80
    s_sub_u32 s30, s2, 37
    s_cmp_ge_u32 s30, 11
    s_cbranch_scc1 L_nopf
    s_getpc_b64 s[30:31]
L_pc:
    v_lshlrev_b32 v2, 7, v0
    v_mov_b32 v3, s31
    v_cmp_gt_u32 vcc, L_end-L_pc, v2
    s_and_saveexec_b64 s[32:33], vcc
    s_cbranch_execz L_nopf
    v_add_co_u32 v2, vcc, s30, v2
    v_addc_co_u32 v3, vcc, 0, v3, vcc
    global_load_dword v255, v[2:3], off
L_nopf:
    s_mov_b64 exec, -1
    v_lshrrev_b32 v1, 6, v0
    v_and_b32 v0, 63, v0
    v_readfirstlane_b32 s3, v1
    s_mov_b32 s60, 0x80000
    s_cmp_lt_u32 s2, 48
    s_cbranch_scc1 L_spare
    s_mov_b32 s98, 1
    s_and_b32 s52, s2, 7
    s_lshr_b32 s53, s2, 3
    s_sub_u32 s53, s53, 6
    s_and_b32 s54, s52, 1
    s_mul_i32 s54, s54, 26
    s_add_u32 s54, s54, s53
    s_lshr_b32 s55, s54, 2
    s_and_b32 s56, s54, 3
    s_lshr_b32 s54, s52, 1
    s_lshl_b32 s54, s54, 2
    s_add_u32 s54, s54, s56
    s_lshl_b32 s26, s54, 6
    s_lshl_b32 s57, s55, 2
    s_add_u32 s26, s26, s57
    s_add_u32 s26, s26, s3
    s_sub_u32 s26, s26, 4
    s_mov_b32 s27, 0
    s_mov_b32 s97, s55
    s_cmp_ge_u32 s3, 4
    s_cbranch_scc1 L_cin
    s_setprio 2
    s_and_b32 s52, s2, 1
    s_mul_i32 s52, s52, 6
    s_sub_u32 s57, s55, s52
    s_lshl_b32 s57, s57, 1
    s_mul_i32 s58, s56, 3
    s_lshl_b32 s56, s3, 11
    s_and_b32 s52, s3, 1
    s_mul_i32 s26, s52, 26624
    s_lshr_b32 s53, s3, 1
    s_mul_i32 s27, s53, 692224
    s_add_u32 s26, s26, s27
    v_lshlrev_b32 v13, 4, v0
    v_lshrrev_b32 v14, 3, v0
    v_and_b32 v15, 7, v0
    v_bfe_u32 v1, v0, 4, 1
    v_lshlrev_b32 v1, 2, v1
    v_xor_b32 v15, v15, v1
    v_lshlrev_b32 v15, 4, v15
    v_mul_u32_u24 v12, 1664, v14
    v_add_u32 v12, v12, v15
    v_lshlrev_b32 v8, 21, v0
    s_lshl_b32 s52, s3, 27
    v_add_u32 v8, s52, v8
    s_add_u32 s52, s57, s58
    s_cmp_ge_u32 s52, 13
    s_cselect_b32 s53, 13, 0
    s_sub_u32 s52, s52, s53
    s_mul_i32 s59, s52, 53248
    s_add_u32 s59, s59, s26
    s_add_u32 s61, s26, 692224
    s_lshl_b32 s48, s58, 13
    s_add_u32 s48, s48, s56
    s_add_u32 s49, s56, 106496
    s_lshl_b32 s52, s3, 2
    s_add_u32 s52, s52, 155648
    v_mov_b32 v58, s52
    v_mov_b32 v1, 0
    ds_write_b32 v58, v1
    v_mov_b32 v59, 155648
    s_lshl_b32 s27, s54, 2
    s_add_u32 s27, s27, s3
    s_mul_i32 s27, s27, 1664
    s_add_u32 m0, s56, 139264
    s_waitcnt lgkmcnt(0)
    s_add_u32 s28, s4, s27
    s_addc_u32 s29, s5, 0
    s_mov_b32 s30, 1664
    s_mov_b32 s31, 0x20000
    buffer_load_dwordx4 v13, s[28:31], 0 offen lds
    buffer_load_dwordx4 v13, s[28:31], 0 offen offset:1024 lds
    s_lshl_b32 s27, s55, 7
    s_mov_b32 s36, s6
    s_mov_b32 s37, s7
    s_mov_b32 s38, 6400000
    s_mov_b32 s39, 0x20000
    buffer_load_dword v64, v8, s[36:39], 0 offen
    s_add_u32 s32, s12, s27
    s_addc_u32 s33, s13, 0
    s_mov_b32 s34, 1382912
    s_mov_b32 s35, 0x20000
    s_lshr_b32 s53, s3, 1
    s_lshl_b32 s53, s53, 6
    s_add_u32 s27, s27, s53
    s_add_u32 s40, s14, s27
    s_addc_u32 s41, s15, 0
    s_mov_b32 s42, 64
    s_mov_b32 s43, 0x20000
    s_add_u32 s44, s16, s27
    s_addc_u32 s45, s17, 0
    s_mov_b32 s46, 64
    s_mov_b32 s47, 0x20000
    v_lshlrev_b32 v9, 1, v0
    v_subrev_u32 v8, 64, v9
    buffer_load_ushort v60, v9, s[40:43], 0 offen
    buffer_load_ushort v61, v8, s[44:47], 0 offen
    s_mov_b32 s50, 3
L_w0:
    s_mov_b32 m0, s48
    s_add_u32 s53, s59, 13312
    buffer_load_dwordx4 v12, s[32:35], s59 offen lds
    s_add_u32 m0, s48, 1024
    s_add_u32 s59, s59, 53248
    buffer_load_dwordx4 v12, s[32:35], s53 offen lds
    s_cmp_ge_u32 s59, s61
    s_cselect_b32 s59, s26, s59
    s_add_u32 s48, s48, 8192
    s_cmp_ge_u32 s48, s49
    s_cselect_b32 s48, s56, s48
    s_sub_u32 s50, s50, 1
    s_cmp_lg_u32 s50, 0
    s_cbranch_scc1 L_w0
    v_bfe_u32 v1, v0, 2, 1
    v_mul_u32_u24 v6, 104, v14
    v_mad_u32_u24 v7, v1, 52, v6
    v_xor_b32 v1, 1, v1
    v_mad_u32_u24 v8, v1, 52, v6
    s_add_u32 s52, s56, 139264
    v_add_u32 v6, s52, v7
    s_add_u32 s52, s52, 832
    v_add_u32 v7, s52, v8
    v_and_b32 v15, 3, v0
    v_lshrrev_b32 v1, 4, v0
    v_xor_b32 v15, v15, v1
    v_lshlrev_b32 v15, 4, v15
    v_and_b32 v1, 31, v0
    s_and_b32 s52, s3, 1
    s_lshl_b32 s52, s52, 5
    v_add_u32 v1, s52, v1
    v_bfe_u32 v8, v1, 1, 3
    v_lshrrev_b32 v9, 5, v0
    v_xor_b32 v8, v8, v9
    v_lshlrev_b32 v1, 7, v1
    v_add_u32 v1, 106496, v1
    v_xor_b32 v2, 0, v8
    v_lshl_add_u32 v2, v2, 4, v1
    v_xor_b32 v3, 2, v8
    v_lshl_add_u32 v3, v3, 4, v1
    v_xor_b32 v4, 4, v8
    v_lshl_add_u32 v4, v4, 4, v1
    v_xor_b32 v5, 6, v8
    v_lshl_add_u32 v5, v5, 4, v1
    v_bfe_u32 v1, v0, 2, 2
    v_lshl_add_u32 v10, v9, 3, v1
    v_lshlrev_b32 v10, 7, v10
    v_lshrrev_b32 v1, 1, v1
    s_lshr_b32 s52, s3, 1
    v_xor_b32 v1, s52, v1
    v_lshl_add_u32 v10, v1, 6, v10
    v_bfe_u32 v1, v0, 4, 1
    v_lshl_add_u32 v10, v1, 5, v10
    v_and_b32 v1, 3, v0
    v_lshl_add_u32 v10, v1, 3, v10
    v_add_u32 v11, 0x10000, v10
    s_lshl_b32 s52, s57, 2
    v_add_u32 v32, s52, v6
    v_add_u32 v45, s52, v7
    s_add_u32 s52, s52, 4
    s_cmp_eq_u32 s52, 52
    s_cselect_b32 s52, 0, s52
    v_add_u32 v33, s52, v6
    v_add_u32 v46, s52, v7
    s_add_u32 s52, s52, 4
    s_cmp_eq_u32 s52, 52
    s_cselect_b32 s52, 0, s52
    v_add_u32 v34, s52, v6
    v_add_u32 v47, s52, v7
    s_add_u32 s52, s52, 4
    s_cmp_eq_u32 s52, 52
    s_cselect_b32 s52, 0, s52
    v_add_u32 v35, s52, v6
    v_add_u32 v48, s52, v7
    s_add_u32 s52, s52, 4
    s_cmp_eq_u32 s52, 52
    s_cselect_b32 s52, 0, s52
    v_add_u32 v36, s52, v6
    v_add_u32 v49, s52, v7
    s_add_u32 s52, s52, 4
    s_cmp_eq_u32 s52, 52
    s_cselect_b32 s52, 0, s52
    v_add_u32 v37, s52, v6
    v_add_u32 v50, s52, v7
    s_add_u32 s52, s52, 4
    s_cmp_eq_u32 s52, 52
    s_cselect_b32 s52, 0, s52
    v_add_u32 v38, s52, v6
    v_add_u32 v51, s52, v7
    s_add_u32 s52, s52, 4
    s_cmp_eq_u32 s52, 52
    s_cselect_b32 s52, 0, s52
    v_add_u32 v39, s52, v6
    v_add_u32 v52, s52, v7
    s_add_u32 s52, s52, 4
    s_cmp_eq_u32 s52, 52
    s_cselect_b32 s52, 0, s52
    v_add_u32 v40, s52, v6
    v_add_u32 v53, s52, v7
    s_add_u32 s52, s52, 4
    s_cmp_eq_u32 s52, 52
    s_cselect_b32 s52, 0, s52
    v_add_u32 v41, s52, v6
    v_add_u32 v54, s52, v7
    s_add_u32 s52, s52, 4
    s_cmp_eq_u32 s52, 52
    s_cselect_b32 s52, 0, s52
    v_add_u32 v42, s52, v6
    v_add_u32 v55, s52, v7
    s_add_u32 s52, s52, 4
    s_cmp_eq_u32 s52, 52
    s_cselect_b32 s52, 0, s52
    v_add_u32 v43, s52, v6
    v_add_u32 v56, s52, v7
    s_add_u32 s52, s52, 4
    s_cmp_eq_u32 s52, 52
    s_cselect_b32 s52, 0, s52
    v_add_u32 v44, s52, v6
    v_add_u32 v57, s52, v7
    s_barrier
    s_mov_b32 s50, 2
L_w1:
    s_mov_b32 m0, s48
    s_add_u32 s53, s59, 13312
    buffer_load_dwordx4 v12, s[32:35], s59 offen lds
    s_add_u32 m0, s48, 1024
    s_add_u32 s59, s59, 53248
    buffer_load_dwordx4 v12, s[32:35], s53 offen lds
    s_cmp_ge_u32 s59, s61
    s_cselect_b32 s59, s26, s59
    s_add_u32 s48, s48, 8192
    s_cmp_ge_u32 s48, s49
    s_cselect_b32 s48, s56, s48
    s_sub_u32 s50, s50, 1
    s_cmp_lg_u32 s50, 0
    s_cbranch_scc1 L_w1
    s_waitcnt vmcnt(10)
    ds_read_b32 v32, v32
    ds_read_b32 v45, v45
    ds_read_b32 v33, v33
    ds_read_b32 v46, v46
    ds_read_b32 v34, v34
    ds_read_b32 v47, v47
    ds_read_b32 v35, v35
    ds_read_b32 v48, v48
    ds_read_b32 v36, v36
    ds_read_b32 v49, v49
    ds_read_b32 v37, v37
    ds_read_b32 v50, v50
    ds_read_b32 v38, v38
    ds_read_b32 v51, v51
    ds_read_b32 v39, v39
    ds_read_b32 v52, v52
    ds_read_b32 v40, v40
    ds_read_b32 v53, v53
    ds_read_b32 v41, v41
    ds_read_b32 v54, v54
    ds_read_b32 v42, v42
    ds_read_b32 v55, v55
    ds_read_b32 v43, v43
    ds_read_b32 v56, v56
    ds_read_b32 v44, v44
    ds_read_b32 v57, v57
    v_or_b32 v60, v60, v61
    v_lshlrev_b32 v60, 16, v60
    s_lshl_b32 s52, s3, 8
    s_add_u32 s52, s52, 155712
    v_lshl_add_u32 v61, v0, 2, s52
    ds_write_b32 v61, v60
    v_lshrrev_b32 v61, 5, v0
    v_lshl_add_u32 v61, v61, 4, s52
    ds_read_b128 v[16:19], v61 offset:0
    ds_read_b128 v[20:23], v61 offset:32
    ds_read_b128 v[24:27], v61 offset:64
    ds_read_b128 v[28:31], v61 offset:96
    ds_read_b128 v[240:243], v61 offset:128
    ds_read_b128 v[244:247], v61 offset:160
    ds_read_b128 v[248:251], v61 offset:192
    ds_read_b128 v[252:255], v61 offset:224
    s_waitcnt lgkmcnt(9)
    v_lshl_add_u32 v32, v32, 6, v15
    v_lshl_add_u32 v45, v45, 6, v15
    v_lshl_add_u32 v33, v33, 6, v15
    v_lshl_add_u32 v46, v46, 6, v15
    v_lshl_add_u32 v34, v34, 6, v15
    v_lshl_add_u32 v47, v47, 6, v15
    v_lshl_add_u32 v35, v35, 6, v15
    v_lshl_add_u32 v48, v48, 6, v15
    v_lshl_add_u32 v36, v36, 6, v15
    v_lshl_add_u32 v49, v49, 6, v15
    v_lshl_add_u32 v37, v37, 6, v15
    v_lshl_add_u32 v50, v50, 6, v15
    v_lshl_add_u32 v38, v38, 6, v15
    v_lshl_add_u32 v51, v51, 6, v15
    v_lshl_add_u32 v39, v39, 6, v15
    v_lshl_add_u32 v52, v52, 6, v15
    v_lshl_add_u32 v40, v40, 6, v15
    v_lshl_add_u32 v53, v53, 6, v15
    v_lshl_add_u32 v41, v41, 6, v15
    v_lshl_add_u32 v54, v54, 6, v15
    v_lshl_add_u32 v42, v42, 6, v15
    v_lshl_add_u32 v55, v55, 6, v15
    v_lshl_add_u32 v43, v43, 6, v15
    v_lshl_add_u32 v56, v56, 6, v15
    v_lshl_add_u32 v44, v44, 6, v15
    v_lshl_add_u32 v57, v57, 6, v15
    s_mov_b32 s50, 8
L_w2:
    s_mov_b32 m0, s48
    s_add_u32 s53, s59, 13312
    buffer_load_dwordx4 v12, s[32:35], s59 offen lds
    s_add_u32 m0, s48, 1024
    s_add_u32 s59, s59, 53248
    buffer_load_dwordx4 v12, s[32:35], s53 offen lds
    s_cmp_ge_u32 s59, s61
    s_cselect_b32 s59, s26, s59
    s_add_u32 s48, s48, 8192
    s_cmp_ge_u32 s48, s49
    s_cselect_b32 s48, s56, s48
    s_sub_u32 s50, s50, 1
    s_cmp_lg_u32 s50, 0
    s_cbranch_scc1 L_w2
    v_mov_b32 v1, 1
    ds_write_b32 v58, v1
    s_add_u32 m0, s56, 106496
    s_nop 0
    buffer_load_dwordx4 v32, s[36:39], 0 offen lds
    s_add_u32 m0, s56, 107520
    s_nop 0
    buffer_load_dwordx4 v45, s[36:39], 0 offen lds
    s_add_u32 m0, s56, 114688
    s_nop 0
    buffer_load_dwordx4 v33, s[36:39], 0 offen lds
    s_add_u32 m0, s56, 115712
    s_nop 0
    buffer_load_dwordx4 v46, s[36:39], 0 offen lds
    s_mov_b32 s40, s22
    s_mov_b32 s41, s23
    s_mov_b32 s42, 256
    s_mov_b32 s43, 0x20000
    s_add_u32 m0, s56, 122880
    s_nop 0
    buffer_load_dwordx4 v34, s[36:39], 0 offen lds
    s_add_u32 m0, s56, 123904
    s_nop 0
    buffer_load_dwordx4 v47, s[36:39], 0 offen lds
    s_add_u32 m0, s56, 131072
    s_nop 0
    buffer_load_dwordx4 v35, s[36:39], 0 offen lds
    s_add_u32 m0, s56, 132096
    s_nop 0
    buffer_load_dwordx4 v48, s[36:39], 0 offen lds
    s_add_u32 m0, s56, 139264
    s_nop 0
    buffer_load_dwordx4 v36, s[36:39], 0 offen lds
    s_add_u32 m0, s56, 140288
    s_nop 0
    buffer_load_dwordx4 v49, s[36:39], 0 offen lds
    s_waitcnt vmcnt(8)
    v_mov_b32 v1, 3
    ds_write_b32 v58, v1
    ds_read_b128 v[60:63], v59
    s_waitcnt lgkmcnt(0)
    v_min3_u32 v60, v60, v61, v62
    v_min_u32 v60, v60, v63
    v_cmp_gt_u32 vcc, 3, v60
    s_cbranch_vccz L_ok3
L_rp3:
    ds_read_b128 v[60:63], v59
    s_sub_u32 s60, s60, 1
    s_cbranch_scc1 L_ok3
    s_waitcnt lgkmcnt(0)
    v_min3_u32 v60, v60, v61, v62
    v_min_u32 v60, v60, v63
    v_cmp_gt_u32 vcc, 3, v60
    s_cbranch_vccnz L_rp3
L_ok3:
    ds_read_b64_tr_b16 v[96:97], v10 offset:0
    ds_read_b64_tr_b16 v[98:99], v10 offset:512
    ds_read_b64_tr_b16 v[100:101], v10 offset:2048
    ds_read_b64_tr_b16 v[102:103], v10 offset:2560
    ds_read_b64_tr_b16 v[104:105], v10 offset:4096
    ds_read_b64_tr_b16 v[106:107], v10 offset:4608
    ds_read_b64_tr_b16 v[108:109], v10 offset:6144
    ds_read_b64_tr_b16 v[110:111], v10 offset:6656
    ds_read_b128 v[64:67], v2 offset:0
    ds_read_b128 v[68:71], v3 offset:0
    ds_read_b128 v[72:75], v4 offset:0
    ds_read_b128 v[76:79], v5 offset:0
    s_waitcnt vmcnt(6)
    v_mov_b32 v1, 4
    ds_write_b32 v58, v1
    ds_read_b128 v[60:63], v59
    ds_read_b64_tr_b16 v[112:113], v10 offset:8192
    ds_read_b64_tr_b16 v[114:115], v10 offset:8704
    ds_read_b64_tr_b16 v[116:117], v10 offset:10240
    ds_read_b64_tr_b16 v[118:119], v10 offset:10752
    ds_read_b64_tr_b16 v[120:121], v10 offset:12288
    ds_read_b64_tr_b16 v[122:123], v10 offset:12800
    ds_read_b64_tr_b16 v[124:125], v10 offset:14336
    ds_read_b64_tr_b16 v[126:127], v10 offset:14848
    s_waitcnt lgkmcnt(10)
    v_mfma_f32_32x32x16_bf16 v[16:31], v[96:99], v[64:67], v[16:31]
    s_waitcnt lgkmcnt(8)
    v_min3_u32 v60, v60, v61, v62
    v_min_u32 v60, v60, v63
    v_cmp_gt_u32 vcc, 4, v60
    s_cbranch_vccz L_ok4
L_rp4:
    ds_read_b128 v[60:63], v59
    s_sub_u32 s60, s60, 1
    s_cbranch_scc1 L_ok4
    s_waitcnt lgkmcnt(0)
    v_min3_u32 v60, v60, v61, v62
    v_min_u32 v60, v60, v63
    v_cmp_gt_u32 vcc, 4, v60
    s_cbranch_vccnz L_rp4
L_ok4:
    ds_read_b128 v[80:83], v2 offset:8192
    ds_read_b128 v[84:87], v3 offset:8192
    ds_read_b128 v[88:91], v4 offset:8192
    ds_read_b128 v[92:95], v5 offset:8192
    v_mfma_f32_32x32x16_bf16 v[16:31], v[100:103], v[68:71], v[16:31]
    s_add_u32 m0, s56, 106496
    s_nop 0
    buffer_load_dwordx4 v37, s[36:39], 0 offen lds
    s_add_u32 m0, s56, 107520
    s_nop 0
    buffer_load_dwordx4 v50, s[36:39], 0 offen lds
    s_waitcnt vmcnt(6)
    v_mov_b32 v1, 5
    ds_write_b32 v58, v1
    ds_read_b128 v[60:63], v59
    v_mfma_f32_32x32x16_bf16 v[16:31], v[104:107], v[72:75], v[16:31]
    ds_read_b64_tr_b16 v[128:129], v10 offset:16384
    ds_read_b64_tr_b16 v[130:131], v10 offset:16896
    ds_read_b64_tr_b16 v[132:133], v10 offset:18432
    ds_read_b64_tr_b16 v[134:135], v10 offset:18944
    ds_read_b64_tr_b16 v[136:137], v10 offset:20480
    ds_read_b64_tr_b16 v[138:139], v10 offset:20992
    ds_read_b64_tr_b16 v[140:141], v10 offset:22528
    ds_read_b64_tr_b16 v[142:143], v10 offset:23040
    v_mfma_f32_32x32x16_bf16 v[16:31], v[108:111], v[76:79], v[16:31]
    s_waitcnt lgkmcnt(10)
    v_mfma_f32_32x32x16_bf16 v[16:31], v[112:115], v[80:83], v[16:31]
    s_waitcnt lgkmcnt(8)
    v_min3_u32 v60, v60, v61, v62
    v_min_u32 v60, v60, v63
    v_cmp_gt_u32 vcc, 5, v60
    s_cbranch_vccz L_ok5
L_rp5:
    ds_read_b128 v[60:63], v59
    s_sub_u32 s60, s60, 1
    s_cbranch_scc1 L_ok5
    s_waitcnt lgkmcnt(0)
    v_min3_u32 v60, v60, v61, v62
    v_min_u32 v60, v60, v63
    v_cmp_gt_u32 vcc, 5, v60
    s_cbranch_vccnz L_rp5
L_ok5:
    ds_read_b128 v[64:67], v2 offset:16384
    ds_read_b128 v[68:71], v3 offset:16384
    ds_read_b128 v[72:75], v4 offset:16384
    ds_read_b128 v[76:79], v5 offset:16384
    v_mfma_f32_32x32x16_bf16 v[16:31], v[116:119], v[84:87], v[16:31]
    s_add_u32 m0, s56, 114688
    s_nop 0
    buffer_load_dwordx4 v38, s[36:39], 0 offen lds
    s_add_u32 m0, s56, 115712
    s_nop 0
    buffer_load_dwordx4 v51, s[36:39], 0 offen lds
    s_waitcnt vmcnt(6)
    v_mov_b32 v1, 6
    ds_write_b32 v58, v1
    ds_read_b128 v[60:63], v59
    v_mfma_f32_32x32x16_bf16 v[16:31], v[120:123], v[88:91], v[16:31]
    ds_read_b64_tr_b16 v[96:97], v10 offset:24576
    ds_read_b64_tr_b16 v[98:99], v10 offset:25088
    ds_read_b64_tr_b16 v[100:101], v10 offset:26624
    ds_read_b64_tr_b16 v[102:103], v10 offset:27136
    ds_read_b64_tr_b16 v[104:105], v10 offset:28672
    ds_read_b64_tr_b16 v[106:107], v10 offset:29184
    ds_read_b64_tr_b16 v[108:109], v10 offset:30720
    ds_read_b64_tr_b16 v[110:111], v10 offset:31232
    v_mfma_f32_32x32x16_bf16 v[16:31], v[124:127], v[92:95], v[16:31]
    s_waitcnt lgkmcnt(10)
    v_mfma_f32_32x32x16_bf16 v[16:31], v[128:131], v[64:67], v[16:31]
    s_waitcnt lgkmcnt(8)
    v_min3_u32 v60, v60, v61, v62
    v_min_u32 v60, v60, v63
    v_cmp_gt_u32 vcc, 6, v60
    s_cbranch_vccz L_ok6
L_rp6:
    ds_read_b128 v[60:63], v59
    s_sub_u32 s60, s60, 1
    s_cbranch_scc1 L_ok6
    s_waitcnt lgkmcnt(0)
    v_min3_u32 v60, v60, v61, v62
    v_min_u32 v60, v60, v63
    v_cmp_gt_u32 vcc, 6, v60
    s_cbranch_vccnz L_rp6
L_ok6:
    ds_read_b128 v[80:83], v2 offset:24576
    ds_read_b128 v[84:87], v3 offset:24576
    ds_read_b128 v[88:91], v4 offset:24576
    ds_read_b128 v[92:95], v5 offset:24576
    v_mfma_f32_32x32x16_bf16 v[16:31], v[132:135], v[68:71], v[16:31]
    s_add_u32 m0, s56, 122880
    s_nop 0
    buffer_load_dwordx4 v39, s[36:39], 0 offen lds
    s_add_u32 m0, s56, 123904
    s_nop 0
    buffer_load_dwordx4 v52, s[36:39], 0 offen lds
    s_waitcnt vmcnt(6)
    v_mov_b32 v1, 7
    ds_write_b32 v58, v1
    ds_read_b128 v[60:63], v59
    v_mfma_f32_32x32x16_bf16 v[16:31], v[136:139], v[72:75], v[16:31]
    ds_read_b64_tr_b16 v[112:113], v10 offset:32768
    ds_read_b64_tr_b16 v[114:115], v10 offset:33280
    ds_read_b64_tr_b16 v[116:117], v10 offset:34816
    ds_read_b64_tr_b16 v[118:119], v10 offset:35328
    ds_read_b64_tr_b16 v[120:121], v10 offset:36864
    ds_read_b64_tr_b16 v[122:123], v10 offset:37376
    ds_read_b64_tr_b16 v[124:125], v10 offset:38912
    ds_read_b64_tr_b16 v[126:127], v10 offset:39424
    v_mfma_f32_32x32x16_bf16 v[16:31], v[140:143], v[76:79], v[16:31]
    s_waitcnt lgkmcnt(10)
    v_mfma_f32_32x32x16_bf16 v[16:31], v[96:99], v[80:83], v[16:31]
    s_waitcnt lgkmcnt(8)
    v_min3_u32 v60, v60, v61, v62
    v_min_u32 v60, v60, v63
    v_cmp_gt_u32 vcc, 7, v60
    s_cbranch_vccz L_ok7
L_rp7:
    ds_read_b128 v[60:63], v59
    s_sub_u32 s60, s60, 1
    s_cbranch_scc1 L_ok7
    s_waitcnt lgkmcnt(0)
    v_min3_u32 v60, v60, v61, v62
    v_min_u32 v60, v60, v63
    v_cmp_gt_u32 vcc, 7, v60
    s_cbranch_vccnz L_rp7
L_ok7:
    ds_read_b128 v[64:67], v2 offset:32768
    ds_read_b128 v[68:71], v3 offset:32768
    ds_read_b128 v[72:75], v4 offset:32768
    ds_read_b128 v[76:79], v5 offset:32768
    v_mfma_f32_32x32x16_bf16 v[16:31], v[100:103], v[84:87], v[16:31]
    s_add_u32 m0, s56, 131072
    s_nop 0
    buffer_load_dwordx4 v40, s[36:39], 0 offen lds
    s_add_u32 m0, s56, 132096
    s_nop 0
    buffer_load_dwordx4 v53, s[36:39], 0 offen lds
    s_waitcnt vmcnt(6)
    v_mov_b32 v1, 8
    ds_write_b32 v58, v1
    ds_read_b128 v[60:63], v59
    v_mfma_f32_32x32x16_bf16 v[16:31], v[104:107], v[88:91], v[16:31]
    ds_read_b64_tr_b16 v[128:129], v10 offset:40960
    ds_read_b64_tr_b16 v[130:131], v10 offset:41472
    ds_read_b64_tr_b16 v[132:133], v10 offset:43008
    ds_read_b64_tr_b16 v[134:135], v10 offset:43520
    ds_read_b64_tr_b16 v[136:137], v10 offset:45056
    ds_read_b64_tr_b16 v[138:139], v10 offset:45568
    ds_read_b64_tr_b16 v[140:141], v10 offset:47104
    ds_read_b64_tr_b16 v[142:143], v10 offset:47616
    v_mfma_f32_32x32x16_bf16 v[16:31], v[108:111], v[92:95], v[16:31]
    s_waitcnt lgkmcnt(10)
    v_mfma_f32_32x32x16_bf16 v[16:31], v[112:115], v[64:67], v[16:31]
    s_waitcnt lgkmcnt(8)
    v_min3_u32 v60, v60, v61, v62
    v_min_u32 v60, v60, v63
    v_cmp_gt_u32 vcc, 8, v60
    s_cbranch_vccz L_ok8
L_rp8:
    ds_read_b128 v[60:63], v59
    s_sub_u32 s60, s60, 1
    s_cbranch_scc1 L_ok8
    s_waitcnt lgkmcnt(0)
    v_min3_u32 v60, v60, v61, v62
    v_min_u32 v60, v60, v63
    v_cmp_gt_u32 vcc, 8, v60
    s_cbranch_vccnz L_rp8
L_ok8:
    ds_read_b128 v[80:83], v2 offset:0
    ds_read_b128 v[84:87], v3 offset:0
    ds_read_b128 v[88:91], v4 offset:0
    ds_read_b128 v[92:95], v5 offset:0
    v_mfma_f32_32x32x16_bf16 v[16:31], v[116:119], v[68:71], v[16:31]
    s_add_u32 m0, s56, 139264
    s_nop 0
    buffer_load_dwordx4 v41, s[36:39], 0 offen lds
    s_add_u32 m0, s56, 140288
    s_nop 0
    buffer_load_dwordx4 v54, s[36:39], 0 offen lds
    s_waitcnt vmcnt(6)
    v_mov_b32 v1, 9
    ds_write_b32 v58, v1
    ds_read_b128 v[60:63], v59
    v_mfma_f32_32x32x16_bf16 v[16:31], v[120:123], v[72:75], v[16:31]
    ds_read_b64_tr_b16 v[96:97], v10 offset:49152
    ds_read_b64_tr_b16 v[98:99], v10 offset:49664
    ds_read_b64_tr_b16 v[100:101], v10 offset:51200
    ds_read_b64_tr_b16 v[102:103], v10 offset:51712
    ds_read_b64_tr_b16 v[104:105], v10 offset:53248
    ds_read_b64_tr_b16 v[106:107], v10 offset:53760
    ds_read_b64_tr_b16 v[108:109], v10 offset:55296
    ds_read_b64_tr_b16 v[110:111], v10 offset:55808
    v_mfma_f32_32x32x16_bf16 v[16:31], v[124:127], v[76:79], v[16:31]
    s_waitcnt lgkmcnt(10)
    v_mfma_f32_32x32x16_bf16 v[16:31], v[128:131], v[80:83], v[16:31]
    s_waitcnt lgkmcnt(8)
    v_min3_u32 v60, v60, v61, v62
    v_min_u32 v60, v60, v63
    v_cmp_gt_u32 vcc, 9, v60
    s_cbranch_vccz L_ok9
L_rp9:
    ds_read_b128 v[60:63], v59
    s_sub_u32 s60, s60, 1
    s_cbranch_scc1 L_ok9
    s_waitcnt lgkmcnt(0)
    v_min3_u32 v60, v60, v61, v62
    v_min_u32 v60, v60, v63
    v_cmp_gt_u32 vcc, 9, v60
    s_cbranch_vccnz L_rp9
L_ok9:
    ds_read_b128 v[64:67], v2 offset:8192
    ds_read_b128 v[68:71], v3 offset:8192
    ds_read_b128 v[72:75], v4 offset:8192
    ds_read_b128 v[76:79], v5 offset:8192
    v_mfma_f32_32x32x16_bf16 v[16:31], v[132:135], v[84:87], v[16:31]
    s_add_u32 m0, s56, 106496
    s_nop 0
    buffer_load_dwordx4 v42, s[36:39], 0 offen lds
    s_add_u32 m0, s56, 107520
    s_nop 0
    buffer_load_dwordx4 v55, s[36:39], 0 offen lds
    s_waitcnt vmcnt(6)
    v_mov_b32 v1, 10
    ds_write_b32 v58, v1
    ds_read_b128 v[60:63], v59
    v_mfma_f32_32x32x16_bf16 v[16:31], v[136:139], v[88:91], v[16:31]
    ds_read_b64_tr_b16 v[112:113], v10 offset:57344
    ds_read_b64_tr_b16 v[114:115], v10 offset:57856
    ds_read_b64_tr_b16 v[116:117], v10 offset:59392
    ds_read_b64_tr_b16 v[118:119], v10 offset:59904
    ds_read_b64_tr_b16 v[120:121], v10 offset:61440
    ds_read_b64_tr_b16 v[122:123], v10 offset:61952
    ds_read_b64_tr_b16 v[124:125], v10 offset:63488
    ds_read_b64_tr_b16 v[126:127], v10 offset:64000
    v_mfma_f32_32x32x16_bf16 v[16:31], v[140:143], v[92:95], v[16:31]
    s_waitcnt lgkmcnt(10)
    v_mfma_f32_32x32x16_bf16 v[16:31], v[96:99], v[64:67], v[16:31]
    s_waitcnt lgkmcnt(8)
    v_min3_u32 v60, v60, v61, v62
    v_min_u32 v60, v60, v63
    v_cmp_gt_u32 vcc, 10, v60
    s_cbranch_vccz L_ok10
L_rp10:
    ds_read_b128 v[60:63], v59
    s_sub_u32 s60, s60, 1
    s_cbranch_scc1 L_ok10
    s_waitcnt lgkmcnt(0)
    v_min3_u32 v60, v60, v61, v62
    v_min_u32 v60, v60, v63
    v_cmp_gt_u32 vcc, 10, v60
    s_cbranch_vccnz L_rp10
L_ok10:
    ds_read_b128 v[80:83], v2 offset:16384
    ds_read_b128 v[84:87], v3 offset:16384
    ds_read_b128 v[88:91], v4 offset:16384
    ds_read_b128 v[92:95], v5 offset:16384
    v_mfma_f32_32x32x16_bf16 v[16:31], v[100:103], v[68:71], v[16:31]
    s_add_u32 m0, s56, 114688
    s_nop 0
    buffer_load_dwordx4 v43, s[36:39], 0 offen lds
    s_add_u32 m0, s56, 115712
    s_nop 0
    buffer_load_dwordx4 v56, s[36:39], 0 offen lds
    s_waitcnt vmcnt(6)
    v_mov_b32 v1, 11
    ds_write_b32 v58, v1
    ds_read_b128 v[60:63], v59
    v_mfma_f32_32x32x16_bf16 v[16:31], v[104:107], v[72:75], v[16:31]
    ds_read_b64_tr_b16 v[128:129], v11 offset:0
    ds_read_b64_tr_b16 v[130:131], v11 offset:512
    ds_read_b64_tr_b16 v[132:133], v11 offset:2048
    ds_read_b64_tr_b16 v[134:135], v11 offset:2560
    ds_read_b64_tr_b16 v[136:137], v11 offset:4096
    ds_read_b64_tr_b16 v[138:139], v11 offset:4608
    ds_read_b64_tr_b16 v[140:141], v11 offset:6144
    ds_read_b64_tr_b16 v[142:143], v11 offset:6656
    v_mfma_f32_32x32x16_bf16 v[16:31], v[108:111], v[76:79], v[16:31]
    s_waitcnt lgkmcnt(10)
    v_mfma_f32_32x32x16_bf16 v[16:31], v[112:115], v[80:83], v[16:31]
    s_waitcnt lgkmcnt(8)
    v_min3_u32 v60, v60, v61, v62
    v_min_u32 v60, v60, v63
    v_cmp_gt_u32 vcc, 11, v60
    s_cbranch_vccz L_ok11
L_rp11:
    ds_read_b128 v[60:63], v59
    s_sub_u32 s60, s60, 1
    s_cbranch_scc1 L_ok11
    s_waitcnt lgkmcnt(0)
    v_min3_u32 v60, v60, v61, v62
    v_min_u32 v60, v60, v63
    v_cmp_gt_u32 vcc, 11, v60
    s_cbranch_vccnz L_rp11
L_ok11:
    ds_read_b128 v[64:67], v2 offset:24576
    ds_read_b128 v[68:71], v3 offset:24576
    ds_read_b128 v[72:75], v4 offset:24576
    ds_read_b128 v[76:79], v5 offset:24576
    v_mfma_f32_32x32x16_bf16 v[16:31], v[116:119], v[84:87], v[16:31]
    s_add_u32 m0, s56, 122880
    s_nop 0
    buffer_load_dwordx4 v44, s[36:39], 0 offen lds
    s_add_u32 m0, s56, 123904
    s_nop 0
    buffer_load_dwordx4 v57, s[36:39], 0 offen lds
    v_mov_b32 v14, 208
    buffer_load_dword v15, v14, s[40:43], 0 offen sc1
    s_waitcnt vmcnt(7)
    v_mov_b32 v1, 12
    ds_write_b32 v58, v1
    ds_read_b128 v[60:63], v59
    v_mfma_f32_32x32x16_bf16 v[16:31], v[120:123], v[88:91], v[16:31]
    ds_read_b64_tr_b16 v[96:97], v11 offset:8192
    ds_read_b64_tr_b16 v[98:99], v11 offset:8704
    ds_read_b64_tr_b16 v[100:101], v11 offset:10240
    ds_read_b64_tr_b16 v[102:103], v11 offset:10752
    ds_read_b64_tr_b16 v[104:105], v11 offset:12288
    ds_read_b64_tr_b16 v[106:107], v11 offset:12800
    ds_read_b64_tr_b16 v[108:109], v11 offset:14336
    ds_read_b64_tr_b16 v[110:111], v11 offset:14848
    v_mfma_f32_32x32x16_bf16 v[16:31], v[124:127], v[92:95], v[16:31]
    s_waitcnt lgkmcnt(10)
    v_mfma_f32_32x32x16_bf16 v[16:31], v[128:131], v[64:67], v[16:31]
    s_waitcnt lgkmcnt(8)
    v_min3_u32 v60, v60, v61, v62
    v_min_u32 v60, v60, v63
    v_cmp_gt_u32 vcc, 12, v60
    s_cbranch_vccz L_ok12
L_rp12:
    ds_read_b128 v[60:63], v59
    s_sub_u32 s60, s60, 1
    s_cbranch_scc1 L_ok12
    s_waitcnt lgkmcnt(0)
    v_min3_u32 v60, v60, v61, v62
    v_min_u32 v60, v60, v63
    v_cmp_gt_u32 vcc, 12, v60
    s_cbranch_vccnz L_rp12
L_ok12:
    ds_read_b128 v[80:83], v2 offset:32768
    ds_read_b128 v[84:87], v3 offset:32768
    ds_read_b128 v[88:91], v4 offset:32768
    ds_read_b128 v[92:95], v5 offset:32768
    v_mfma_f32_32x32x16_bf16 v[16:31], v[132:135], v[68:71], v[16:31]
    s_waitcnt vmcnt(5)
    v_mov_b32 v1, 13
    ds_write_b32 v58, v1
    ds_read_b128 v[60:63], v59
    v_mfma_f32_32x32x16_bf16 v[16:31], v[136:139], v[72:75], v[16:31]
    ds_read_b64_tr_b16 v[112:113], v11 offset:16384
    ds_read_b64_tr_b16 v[114:115], v11 offset:16896
    ds_read_b64_tr_b16 v[116:117], v11 offset:18432
    ds_read_b64_tr_b16 v[118:119], v11 offset:18944
    ds_read_b64_tr_b16 v[120:121], v11 offset:20480
    ds_read_b64_tr_b16 v[122:123], v11 offset:20992
    ds_read_b64_tr_b16 v[124:125], v11 offset:22528
    ds_read_b64_tr_b16 v[126:127], v11 offset:23040
    v_mfma_f32_32x32x16_bf16 v[16:31], v[140:143], v[76:79], v[16:31]
    s_waitcnt lgkmcnt(10)
    v_mfma_f32_32x32x16_bf16 v[16:31], v[96:99], v[80:83], v[16:31]
    s_waitcnt lgkmcnt(8)
    v_min3_u32 v60, v60, v61, v62
    v_min_u32 v60, v60, v63
    v_cmp_gt_u32 vcc, 13, v60
    s_cbranch_vccz L_ok13
L_rp13:
    ds_read_b128 v[60:63], v59
    s_sub_u32 s60, s60, 1
    s_cbranch_scc1 L_ok13
    s_waitcnt lgkmcnt(0)
    v_min3_u32 v60, v60, v61, v62
    v_min_u32 v60, v60, v63
    v_cmp_gt_u32 vcc, 13, v60
    s_cbranch_vccnz L_rp13
L_ok13:
    ds_read_b128 v[64:67], v2 offset:0
    ds_read_b128 v[68:71], v3 offset:0
    ds_read_b128 v[72:75], v4 offset:0
    ds_read_b128 v[76:79], v5 offset:0
    v_mfma_f32_32x32x16_bf16 v[16:31], v[100:103], v[84:87], v[16:31]
    s_waitcnt vmcnt(3)
    v_mov_b32 v1, 14
    ds_write_b32 v58, v1
    ds_read_b128 v[60:63], v59
    v_mfma_f32_32x32x16_bf16 v[16:31], v[104:107], v[88:91], v[16:31]
    ds_read_b64_tr_b16 v[128:129], v11 offset:24576
    ds_read_b64_tr_b16 v[130:131], v11 offset:25088
    ds_read_b64_tr_b16 v[132:133], v11 offset:26624
    ds_read_b64_tr_b16 v[134:135], v11 offset:27136
    ds_read_b64_tr_b16 v[136:137], v11 offset:28672
    ds_read_b64_tr_b16 v[138:139], v11 offset:29184
    ds_read_b64_tr_b16 v[140:141], v11 offset:30720
    ds_read_b64_tr_b16 v[142:143], v11 offset:31232
    v_mfma_f32_32x32x16_bf16 v[16:31], v[108:111], v[92:95], v[16:31]
    s_waitcnt lgkmcnt(10)
    v_mfma_f32_32x32x16_bf16 v[16:31], v[112:115], v[64:67], v[16:31]
    s_waitcnt lgkmcnt(8)
    v_min3_u32 v60, v60, v61, v62
    v_min_u32 v60, v60, v63
    v_cmp_gt_u32 vcc, 14, v60
    s_cbranch_vccz L_ok14
L_rp14:
    ds_read_b128 v[60:63], v59
    s_sub_u32 s60, s60, 1
    s_cbranch_scc1 L_ok14
    s_waitcnt lgkmcnt(0)
    v_min3_u32 v60, v60, v61, v62
    v_min_u32 v60, v60, v63
    v_cmp_gt_u32 vcc, 14, v60
    s_cbranch_vccnz L_rp14
L_ok14:
    ds_read_b128 v[80:83], v2 offset:8192
    ds_read_b128 v[84:87], v3 offset:8192
    ds_read_b128 v[88:91], v4 offset:8192
    ds_read_b128 v[92:95], v5 offset:8192
    v_mfma_f32_32x32x16_bf16 v[16:31], v[116:119], v[68:71], v[16:31]
    s_waitcnt vmcnt(1)
    v_mov_b32 v1, 15
    ds_write_b32 v58, v1
    ds_read_b128 v[60:63], v59
    v_mfma_f32_32x32x16_bf16 v[16:31], v[120:123], v[72:75], v[16:31]
    ds_read_b64_tr_b16 v[96:97], v11 offset:32768
    ds_read_b64_tr_b16 v[98:99], v11 offset:33280
    ds_read_b64_tr_b16 v[100:101], v11 offset:34816
    ds_read_b64_tr_b16 v[102:103], v11 offset:35328
    ds_read_b64_tr_b16 v[104:105], v11 offset:36864
    ds_read_b64_tr_b16 v[106:107], v11 offset:37376
    ds_read_b64_tr_b16 v[108:109], v11 offset:38912
    ds_read_b64_tr_b16 v[110:111], v11 offset:39424
    v_mfma_f32_32x32x16_bf16 v[16:31], v[124:127], v[76:79], v[16:31]
    s_waitcnt lgkmcnt(10)
    v_mfma_f32_32x32x16_bf16 v[16:31], v[128:131], v[80:83], v[16:31]
    s_waitcnt lgkmcnt(8)
    v_min3_u32 v60, v60, v61, v62
    v_min_u32 v60, v60, v63
    v_cmp_gt_u32 vcc, 15, v60
    s_cbranch_vccz L_ok15
L_rp15:
    ds_read_b128 v[60:63], v59
    s_sub_u32 s60, s60, 1
    s_cbranch_scc1 L_ok15
    s_waitcnt lgkmcnt(0)
    v_min3_u32 v60, v60, v61, v62
    v_min_u32 v60, v60, v63
    v_cmp_gt_u32 vcc, 15, v60
    s_cbranch_vccnz L_rp15
L_ok15:
    ds_read_b128 v[64:67], v2 offset:16384
    ds_read_b128 v[68:71], v3 offset:16384
    ds_read_b128 v[72:75], v4 offset:16384
    ds_read_b128 v[76:79], v5 offset:16384
    v_mfma_f32_32x32x16_bf16 v[16:31], v[132:135], v[84:87], v[16:31]
    v_mfma_f32_32x32x16_bf16 v[16:31], v[136:139], v[88:91], v[16:31]
    v_mfma_f32_32x32x16_bf16 v[16:31], v[140:143], v[92:95], v[16:31]
    s_waitcnt lgkmcnt(3)
    v_mfma_f32_32x32x16_bf16 v[16:31], v[96:99], v[64:67], v[16:31]
    s_waitcnt lgkmcnt(2)
    v_mfma_f32_32x32x16_bf16 v[16:31], v[100:103], v[68:71], v[16:31]
    s_waitcnt lgkmcnt(1)
    v_mfma_f32_32x32x16_bf16 v[16:31], v[104:107], v[72:75], v[16:31]
    s_waitcnt lgkmcnt(0)
    v_mfma_f32_32x32x16_bf16 v[16:31], v[108:111], v[76:79], v[16:31]
    v_mov_b32 v160, 0xc0135761
    v_mov_b32 v162, 0xbdd2d3e8
    v_mov_b32 v166, 0
    v_mov_b32 v167, 0
    s_lshl_b32 s52, s55, 1
    s_lshr_b32 s53, s3, 1
    s_add_u32 s52, s52, s53
    s_lshl_b32 s52, s52, 13
    s_lshl_b32 s53, s54, 9
    s_add_u32 s52, s52, s53
    s_and_b32 s53, s3, 1
    s_lshl_b32 s53, s53, 8
    s_add_u32 s52, s52, s53
    s_add_u32 s52, s52, 65536
    s_add_u32 s44, s24, s52
    s_addc_u32 s45, s25, 0
    s_mov_b32 s46, 256
    s_mov_b32 s47, 0x20000
    v_lshlrev_b32 v13, 3, v0
    s_lshl_b32 s52, s3, 8
    s_add_u32 s52, s52, 155712
    v_lshl_add_u32 v12, v0, 2, s52
    s_nop 3
    v_mul_f32 v168, v16, v16
    v_mul_f32 v169, v17, v17
    v_mul_f32 v170, v18, v18
    v_mul_f32 v171, v19, v19
    v_mul_f32 v172, v20, v20
    v_mul_f32 v173, v21, v21
    v_mul_f32 v174, v22, v22
    v_mul_f32 v175, v23, v23
    v_mul_f32 v176, v24, v24
    v_mul_f32 v177, v25, v25
    v_mul_f32 v178, v26, v26
    v_mul_f32 v179, v27, v27
    v_mul_f32 v180, v28, v28
    v_mul_f32 v181, v29, v29
    v_mul_f32 v182, v30, v30
    v_mul_f32 v183, v31, v31
    v_fma_f32 v168, v168, v162, v160
    v_fma_f32 v169, v169, v162, v160
    v_fma_f32 v170, v170, v162, v160
    v_fma_f32 v171, v171, v162, v160
    v_fma_f32 v172, v172, v162, v160
    v_fma_f32 v173, v173, v162, v160
    v_fma_f32 v174, v174, v162, v160
    v_fma_f32 v175, v175, v162, v160
    v_fma_f32 v176, v176, v162, v160
    v_fma_f32 v177, v177, v162, v160
    v_fma_f32 v178, v178, v162, v160
    v_fma_f32 v179, v179, v162, v160
    v_fma_f32 v180, v180, v162, v160
    v_fma_f32 v181, v181, v162, v160
    v_fma_f32 v182, v182, v162, v160
    v_fma_f32 v183, v183, v162, v160
    v_mul_f32 v168, v168, v16
    v_mul_f32 v169, v169, v17
    v_mul_f32 v170, v170, v18
    v_mul_f32 v171, v171, v19
    v_mul_f32 v172, v172, v20
    v_mul_f32 v173, v173, v21
    v_mul_f32 v174, v174, v22
    v_mul_f32 v175, v175, v23
    v_mul_f32 v176, v176, v24
    v_mul_f32 v177, v177, v25
    v_mul_f32 v178, v178, v26
    v_mul_f32 v179, v179, v27
    v_mul_f32 v180, v180, v28
    v_mul_f32 v181, v181, v29
    v_mul_f32 v182, v182, v30
    v_mul_f32 v183, v183, v31
    v_exp_f32 v168, v168
    v_mul_f32 v16, v16, v240
    v_exp_f32 v169, v169
    v_mul_f32 v17, v17, v241
    v_exp_f32 v170, v170
    v_mul_f32 v18, v18, v242
    v_exp_f32 v171, v171
    v_mul_f32 v19, v19, v243
    v_exp_f32 v172, v172
    v_mul_f32 v20, v20, v244
    v_exp_f32 v173, v173
    v_mul_f32 v21, v21, v245
    v_exp_f32 v174, v174
    v_mul_f32 v22, v22, v246
    v_exp_f32 v175, v175
    v_mul_f32 v23, v23, v247
    v_exp_f32 v176, v176
    v_mul_f32 v24, v24, v248
    v_exp_f32 v177, v177
    v_mul_f32 v25, v25, v249
    v_exp_f32 v178, v178
    v_mul_f32 v26, v26, v250
    v_exp_f32 v179, v179
    v_mul_f32 v27, v27, v251
    v_exp_f32 v180, v180
    v_mul_f32 v28, v28, v252
    v_exp_f32 v181, v181
    v_mul_f32 v29, v29, v253
    v_exp_f32 v182, v182
    v_mul_f32 v30, v30, v254
    v_exp_f32 v183, v183
    v_mul_f32 v31, v31, v255
    v_add_f32 v168, 1.0, v168
    v_add_f32 v169, 1.0, v169
    v_add_f32 v170, 1.0, v170
    v_add_f32 v171, 1.0, v171
    v_add_f32 v172, 1.0, v172
    v_add_f32 v173, 1.0, v173
    v_add_f32 v174, 1.0, v174
    v_add_f32 v175, 1.0, v175
    v_add_f32 v176, 1.0, v176
    v_add_f32 v177, 1.0, v177
    v_add_f32 v178, 1.0, v178
    v_add_f32 v179, 1.0, v179
    v_add_f32 v180, 1.0, v180
    v_add_f32 v181, 1.0, v181
    v_add_f32 v182, 1.0, v182
    v_add_f32 v183, 1.0, v183
    v_rcp_f32 v168, v168
    v_rcp_f32 v169, v169
    v_rcp_f32 v170, v170
    v_fmac_f32 v166, v168, v16
    v_rcp_f32 v171, v171
    v_fmac_f32 v167, v169, v17
    v_rcp_f32 v172, v172
    v_fmac_f32 v166, v170, v18
    v_rcp_f32 v173, v173
    v_fmac_f32 v167, v171, v19
    v_rcp_f32 v174, v174
    v_fmac_f32 v166, v172, v20
    v_rcp_f32 v175, v175
    v_fmac_f32 v167, v173, v21
    v_rcp_f32 v176, v176
    v_fmac_f32 v166, v174, v22
    v_rcp_f32 v177, v177
    v_fmac_f32 v167, v175, v23
    v_rcp_f32 v178, v178
    v_fmac_f32 v166, v176, v24
    v_rcp_f32 v179, v179
    v_fmac_f32 v167, v177, v25
    v_rcp_f32 v180, v180
    v_fmac_f32 v166, v178, v26
    v_rcp_f32 v181, v181
    v_fmac_f32 v167, v179, v27
    v_rcp_f32 v182, v182
    v_fmac_f32 v166, v180, v28
    v_rcp_f32 v183, v183
    v_fmac_f32 v167, v181, v29
    s_nop 0
    v_fmac_f32 v166, v182, v30
    v_fmac_f32 v167, v183, v31
    v_add_f32 v166, v166, v167
    v_mov_b32 v167, v166
    s_nop 1
    v_permlane32_swap_b32 v166, v167
    s_waitcnt vmcnt(0)
    v_add_f32 v166, v166, v167
    v_cmp_eq_u32 vcc, 0, v15
    s_cbranch_vccz L_nz
    s_mov_b32 s52, 131072
L_nzp:
    buffer_load_dword v15, v14, s[40:43], 0 offen sc1
    s_sub_u32 s52, s52, 1
    s_waitcnt vmcnt(0)
    s_cbranch_scc1 L_nz
    v_cmp_eq_u32 vcc, 0, v15
    s_cbranch_vccnz L_nzp
L_nz:
    v_mov_b32 v167, v15
    s_mov_b32 exec_hi, 0

    buffer_store_dwordx2 v[166:167], v13, s[44:47], 0 offen sc1
    s_endpgm
L_spare:
    s_mov_b32 s98, 0
    s_mov_b32 s97, 0
    s_cmp_lt_u32 s2, 13
    s_cbranch_scc1 L_prod
    s_cmp_ge_u32 s2, 37
    s_cbranch_scc1 L_endw
    s_sub_u32 s52, s2, 13
    s_lshl_b32 s52, s52, 3
    s_add_u32 s52, s52, s3

    s_mul_i32 s53, s52, 171
    s_lshr_b32 s53, s53, 11
    s_mul_i32 s54, s53, 12
    s_sub_u32 s54, s52, s54
    s_lshl_b32 s26, s53, 6
    s_add_u32 s26, s26, s54
    s_add_u32 s26, s26, 52
    s_sub_u32 s27, s3, 1
    s_cmp_lt_u32 s27, 3
    s_cselect_b32 s27, 99, 0
L_cin:
    s_lshl_b32 s56, s3, 11
    s_add_u32 s52, s56, 139264
    s_add_u32 s56, s56, 106496
    s_cmp_lt_u32 s3, 4
    s_cselect_b32 s56, s56, s52
    v_lshrrev_b32 v1, 2, v0
    v_lshlrev_b32 v2, 2, v1
    v_add_u32 v3, 16, v1
    v_subrev_u32 v4, 26, v3
    v_min_u32 v3, v3, v4
    v_lshlrev_b32 v3, 2, v3
    v_and_b32 v4, 3, v0
    v_lshlrev_b32 v4, 4, v4
    s_mul_i32 s53, s26, 104
    s_lshl_b32 s52, s3, 2
    s_add_u32 s52, s52, 155648
    v_mov_b32 v8, s52
    v_mov_b32 v1, s27
    ds_write_b32 v8, v1
    v_mov_b32 v9, 155648
    s_waitcnt lgkmcnt(0)
    s_add_u32 s28, s4, s53
    s_addc_u32 s29, s5, 0
    s_mov_b32 s30, 104
    s_mov_b32 s31, 0x20000
    buffer_load_dword v5, v2, s[28:31], 0 offen
    buffer_load_dword v6, v3, s[28:31], 0 offen
    s_mov_b32 s36, s6
    s_mov_b32 s37, s7
    s_mov_b32 s38, 6400000
    s_mov_b32 s39, 0x20000
    s_mov_b32 s40, s22
    s_mov_b32 s41, s23
    s_mov_b32 s42, 256
    s_mov_b32 s43, 0x20000
    s_mov_b32 s28, s24
    s_mov_b32 s29, s25
    s_mov_b32 s30, 39104
    s_mov_b32 s31, 0x20000
    s_lshl_b32 s52, s26, 1
    s_add_u32 s44, s20, s52
    s_addc_u32 s45, s21, 0
    s_mov_b32 s46, 2
    s_mov_b32 s47, 0x20000
    v_mov_b32 v7, 0
    s_cmp_lg_u32 s3, 4
    s_cbranch_scc1 L_tt1
    buffer_load_dword v19, v7, s[40:43], 0 offen offset:252
L_tt1:
    s_cmp_lg_u32 s3, 5
    s_cbranch_scc1 L_tt2
    buffer_load_ushort v19, v7, s[44:47], 0 offen
L_tt2:
    s_cmp_lg_u32 s3, 6
    s_cbranch_scc1 L_tt3
    s_add_u32 s32, s24, 61440
    s_addc_u32 s33, s25, 0
    s_mov_b32 s34, 4
    s_mov_b32 s35, 0x20000
    buffer_load_dword v19, v7, s[32:35], 0 offen
L_tt3:
    v_mov_b32 v32, 0
    v_mov_b32 v33, 0
    v_mov_b32 v34, 0
    v_mov_b32 v35, 0
    v_mov_b32 v36, 0
    v_mov_b32 v37, 0
    v_mov_b32 v38, 0
    v_mov_b32 v39, 0
    v_mov_b32 v40, 0
    v_mov_b32 v41, 0
    v_mov_b32 v42, 0
    v_mov_b32 v43, 0
    v_mov_b32 v44, 0
    v_mov_b32 v45, 0
    v_mov_b32 v46, 0
    v_mov_b32 v47, 0
    v_mov_b32 v48, 0
    v_mov_b32 v49, 0
    v_mov_b32 v50, 0
    v_mov_b32 v51, 0
    v_mov_b32 v52, 0
    v_mov_b32 v53, 0
    v_mov_b32 v54, 0
    v_mov_b32 v55, 0
    v_mov_b32 v56, 0
    v_mov_b32 v57, 0
    v_and_b32 v1, 31, v0
    v_lshrrev_b32 v7, 5, v0
    v_lshlrev_b32 v10, 1, v1
    v_lshl_add_u32 v10, v7, 6, v10
    v_add_u32 v10, s56, v10
    v_lshrrev_b32 v2, 2, v1
    v_mov_b32 v3, 0x04110d00
    s_mov_b32 s57, 0x190c0815
    v_perm_b32 v2, s57, v3, v2
    v_and_b32 v2, 0xff, v2
    v_and_b32 v1, 3, v0
    v_add_u32 v2, v2, v1
    v_mul_u32_u24 v11, 720, v2
    v_mul_u32_u24 v12, 784, v2
    v_lshl_add_u32 v11, v7, 4, v11
    v_lshl_add_u32 v12, v7, 4, v12
    v_add_u32 v11, 0, v11
    v_add_u32 v12, 18720, v12
    v_lshlrev_b32 v13, 4, v0
    v_add_u32 v14, 0x1000, v13
    v_lshlrev_b32 v15, 2, v0
    s_barrier
    s_cmp_eq_u32 s98, 0
    s_cbranch_scc1 L_pcwx
L_pcw:
    ds_read_b128 v[20:23], v9 offset:0
    s_waitcnt lgkmcnt(0)
    v_min3_u32 v20, v20, v21, v22
    v_min_u32 v20, v20, v23
    v_cmp_gt_u32 vcc, 1, v20
    s_cbranch_vccz L_pcwx
    s_sleep 1
    s_sub_u32 s60, s60, 1
    s_cbranch_scc0 L_pcw
L_pcwx:
    s_waitcnt lgkmcnt(0)
    s_mov_b32 m0, s56
    s_waitcnt vmcnt(0)
    v_lshl_add_u32 v5, v5, 6, v4
    v_lshl_add_u32 v6, v6, 6, v4
    buffer_load_dwordx4 v5, s[36:39], 0 offen lds
    s_add_u32 m0, s56, 1024
    s_mov_b32 exec_hi, 0xfff
    buffer_load_dwordx4 v6, s[36:39], 0 offen lds
    s_mov_b32 exec_hi, -1
    s_and_b32 s52, s3, 3
    s_mul_i32 s57, s52, 5120
    s_add_u32 s58, s57, 4096
    s_add_u32 s59, s57, 20480
    s_add_u32 s55, s57, 24576
    s_lshl_b32 s52, s26, 3
    s_add_u32 s52, s52, 65536
    s_add_u32 s48, s24, s52
    s_addc_u32 s49, s25, 0
    s_mov_b32 s50, 204808
    s_mov_b32 s51, 0x20000
    s_mov_b32 s96, 0
    s_mov_b32 s95, 0
    s_mov_b32 s32, s18
    s_mov_b32 s33, s19
    s_mov_b32 s34, 2
    s_mov_b32 s35, 0x20000
    s_mov_b32 s99, 0x3ffffff
    v_mov_b32 v16, 208
    v_mov_b32 v17, 0x40000000
    v_lshlrev_b32 v14, 13, v0
    v_cmp_gt_u32 vcc, 26, v0
    s_nop 1
    v_cndmask_b32 v14, v17, v14, vcc
    v_mov_b32 v17, 0
    s_waitcnt vmcnt(0)
    ds_read_u16_d16_hi v32, v10 offset:0
    ds_read_u16_d16_hi v33, v10 offset:64
    ds_read_u16_d16_hi v34, v10 offset:128
    ds_read_u16_d16_hi v35, v10 offset:192
    ds_read_u16_d16_hi v36, v10 offset:256
    ds_read_u16_d16_hi v37, v10 offset:320
    ds_read_u16_d16_hi v38, v10 offset:384
    ds_read_u16_d16_hi v39, v10 offset:448
    ds_read_u16_d16_hi v40, v10 offset:512
    ds_read_u16_d16_hi v41, v10 offset:576
    ds_read_u16_d16_hi v42, v10 offset:640
    ds_read_u16_d16_hi v43, v10 offset:704
    ds_read_u16_d16_hi v44, v10 offset:768
    ds_read_u16_d16_hi v45, v10 offset:832
    ds_read_u16_d16_hi v46, v10 offset:896
    ds_read_u16_d16_hi v47, v10 offset:960
    ds_read_u16_d16_hi v48, v10 offset:1024
    ds_read_u16_d16_hi v49, v10 offset:1088
    ds_read_u16_d16_hi v50, v10 offset:1152
    ds_read_u16_d16_hi v51, v10 offset:1216
    ds_read_u16_d16_hi v52, v10 offset:1280
    ds_read_u16_d16_hi v53, v10 offset:1344
    ds_read_u16_d16_hi v54, v10 offset:1408
    ds_read_u16_d16_hi v55, v10 offset:1472
    ds_read_u16_d16_hi v56, v10 offset:1536
    ds_read_u16_d16_hi v57, v10 offset:1600
    s_waitcnt lgkmcnt(0)
    v_mul_f32 v18, v32, v32
    v_mul_f32 v19, v34, v34
    v_cvt_pk_bf16_f32 v64, v18, v19
    v_mul_f32 v20, v36, v36
    v_mul_f32 v21, v38, v38
    v_cvt_pk_bf16_f32 v65, v20, v21
    v_mul_f32 v22, v40, v40
    v_mul_f32 v23, v42, v42
    v_cvt_pk_bf16_f32 v66, v22, v23
    v_mul_f32 v24, v44, v44
    v_mul_f32 v25, v46, v46
    v_cvt_pk_bf16_f32 v67, v24, v25
    v_mul_f32 v18, v48, v48
    v_mul_f32 v19, v50, v50
    v_cvt_pk_bf16_f32 v68, v18, v19
    v_mul_f32 v20, v52, v52
    v_mul_f32 v21, v54, v54
    v_cvt_pk_bf16_f32 v69, v20, v21
    v_mul_f32 v22, v56, v56
    v_mul_f32 v23, v32, v33
    v_cvt_pk_bf16_f32 v70, v22, v23
    v_mul_f32 v24, v34, v35
    v_mul_f32 v25, v36, v37
    v_cvt_pk_bf16_f32 v71, v24, v25
    v_mul_f32 v18, v38, v39
    v_mul_f32 v19, v40, v41
    v_cvt_pk_bf16_f32 v72, v18, v19
    v_mul_f32 v20, v42, v43
    v_mul_f32 v21, v44, v45
    v_cvt_pk_bf16_f32 v73, v20, v21
    v_mul_f32 v22, v46, v47
    v_mul_f32 v23, v48, v49
    v_cvt_pk_bf16_f32 v74, v22, v23
    v_mul_f32 v24, v50, v51
    v_mul_f32 v25, v52, v53
    v_cvt_pk_bf16_f32 v75, v24, v25
    v_mul_f32 v18, v54, v55
    v_mul_f32 v19, v56, v57
    v_cvt_pk_bf16_f32 v76, v18, v19
    v_mul_f32 v20, v32, v34
    v_mul_f32 v21, v34, v36
    v_cvt_pk_bf16_f32 v77, v20, v21
    v_mul_f32 v22, v36, v38
    v_mul_f32 v23, v38, v40
    v_cvt_pk_bf16_f32 v78, v22, v23
    v_mul_f32 v24, v40, v42
    v_mul_f32 v25, v42, v44
    v_cvt_pk_bf16_f32 v79, v24, v25
    v_mul_f32 v18, v44, v46
    v_mul_f32 v19, v46, v48
    v_cvt_pk_bf16_f32 v80, v18, v19
    v_mul_f32 v20, v48, v50
    v_mul_f32 v21, v50, v52
    v_cvt_pk_bf16_f32 v81, v20, v21
    v_mul_f32 v22, v52, v54
    v_mul_f32 v23, v54, v56
    v_cvt_pk_bf16_f32 v82, v22, v23
    v_mul_f32 v24, v56, v32
    v_mul_f32 v25, v32, v35
    v_cvt_pk_bf16_f32 v83, v24, v25
    v_mul_f32 v18, v34, v37
    v_mul_f32 v19, v36, v39
    v_cvt_pk_bf16_f32 v84, v18, v19
    v_mul_f32 v20, v38, v41
    v_mul_f32 v21, v40, v43
    v_cvt_pk_bf16_f32 v85, v20, v21
    v_mul_f32 v22, v42, v45
    v_mul_f32 v23, v44, v47
    v_cvt_pk_bf16_f32 v86, v22, v23
    v_mul_f32 v24, v46, v49
    v_mul_f32 v25, v48, v51
    v_cvt_pk_bf16_f32 v87, v24, v25
    v_mul_f32 v18, v50, v53
    v_mul_f32 v19, v52, v55
    v_cvt_pk_bf16_f32 v88, v18, v19
    v_mul_f32 v20, v54, v57
    v_mul_f32 v21, v56, v33
    v_cvt_pk_bf16_f32 v89, v20, v21
    v_mul_f32 v22, v32, v36
    v_mul_f32 v23, v34, v38
    v_cvt_pk_bf16_f32 v90, v22, v23
    v_mul_f32 v24, v36, v40
    v_mul_f32 v25, v38, v42
    v_cvt_pk_bf16_f32 v91, v24, v25
    v_mul_f32 v18, v40, v44
    v_mul_f32 v19, v42, v46
    v_cvt_pk_bf16_f32 v92, v18, v19
    v_mul_f32 v20, v44, v48
    v_mul_f32 v21, v46, v50
    v_cvt_pk_bf16_f32 v93, v20, v21
    v_mul_f32 v22, v48, v52
    v_mul_f32 v23, v50, v54
    v_cvt_pk_bf16_f32 v94, v22, v23
    v_mul_f32 v24, v52, v56
    v_mul_f32 v25, v54, v32
    v_cvt_pk_bf16_f32 v95, v24, v25
    v_mul_f32 v18, v56, v34
    v_mul_f32 v19, v32, v37
    v_cvt_pk_bf16_f32 v96, v18, v19
    v_mul_f32 v20, v34, v39
    v_mul_f32 v21, v36, v41
    v_cvt_pk_bf16_f32 v97, v20, v21
    v_mul_f32 v22, v38, v43
    v_mul_f32 v23, v40, v45
    v_cvt_pk_bf16_f32 v98, v22, v23
    v_mul_f32 v24, v42, v47
    v_mul_f32 v25, v44, v49
    v_cvt_pk_bf16_f32 v99, v24, v25
    v_mul_f32 v18, v46, v51
    v_mul_f32 v19, v48, v53
    v_cvt_pk_bf16_f32 v100, v18, v19
    v_mul_f32 v20, v50, v55
    v_mul_f32 v21, v52, v57
    v_cvt_pk_bf16_f32 v101, v20, v21
    v_mul_f32 v22, v54, v33
    v_mul_f32 v23, v56, v35
    v_cvt_pk_bf16_f32 v102, v22, v23
    v_mul_f32 v24, v32, v38
    v_mul_f32 v25, v34, v40
    v_cvt_pk_bf16_f32 v103, v24, v25
    v_mul_f32 v18, v36, v42
    v_mul_f32 v19, v38, v44
    v_cvt_pk_bf16_f32 v104, v18, v19
    v_mul_f32 v20, v40, v46
    v_mul_f32 v21, v42, v48
    v_cvt_pk_bf16_f32 v105, v20, v21
    v_mul_f32 v22, v44, v50
    v_mul_f32 v23, v46, v52
    v_cvt_pk_bf16_f32 v106, v22, v23
    v_mul_f32 v24, v48, v54
    v_mul_f32 v25, v50, v56
    v_cvt_pk_bf16_f32 v107, v24, v25
    v_mul_f32 v18, v52, v32
    v_mul_f32 v19, v54, v34
    v_cvt_pk_bf16_f32 v108, v18, v19
    v_mul_f32 v20, v56, v36
    v_mul_f32 v21, v32, v39
    v_cvt_pk_bf16_f32 v109, v20, v21
    v_mul_f32 v22, v34, v41
    v_mul_f32 v23, v36, v43
    v_cvt_pk_bf16_f32 v110, v22, v23
    v_mul_f32 v24, v38, v45
    v_mul_f32 v25, v40, v47
    v_cvt_pk_bf16_f32 v111, v24, v25
    v_mul_f32 v18, v42, v49
    v_mul_f32 v19, v44, v51
    v_cvt_pk_bf16_f32 v112, v18, v19
    v_mul_f32 v20, v46, v53
    v_mul_f32 v21, v48, v55
    v_cvt_pk_bf16_f32 v113, v20, v21
    v_mul_f32 v22, v50, v57
    v_mul_f32 v23, v52, v33
    v_cvt_pk_bf16_f32 v114, v22, v23
    v_mul_f32 v24, v54, v35
    v_mul_f32 v25, v56, v37
    v_cvt_pk_bf16_f32 v115, v24, v25
    v_mul_f32 v18, v32, v40
    v_mul_f32 v19, v34, v42
    v_cvt_pk_bf16_f32 v116, v18, v19
    v_mul_f32 v20, v36, v44
    v_mul_f32 v21, v38, v46
    v_cvt_pk_bf16_f32 v117, v20, v21
    v_mul_f32 v22, v40, v48
    v_mul_f32 v23, v42, v50
    v_cvt_pk_bf16_f32 v118, v22, v23
    v_mul_f32 v24, v44, v52
    v_mul_f32 v25, v46, v54
    v_cvt_pk_bf16_f32 v119, v24, v25
    v_mul_f32 v18, v48, v56
    v_mul_f32 v19, v50, v32
    v_cvt_pk_bf16_f32 v120, v18, v19
    v_mul_f32 v20, v52, v34
    v_mul_f32 v21, v54, v36
    v_cvt_pk_bf16_f32 v121, v20, v21
    v_mul_f32 v22, v56, v38
    v_mul_f32 v23, v32, v41
    v_cvt_pk_bf16_f32 v122, v22, v23
    v_mul_f32 v24, v34, v43
    v_mul_f32 v25, v36, v45
    v_cvt_pk_bf16_f32 v123, v24, v25
    v_mul_f32 v18, v38, v47
    v_mul_f32 v19, v40, v49
    v_cvt_pk_bf16_f32 v124, v18, v19
    v_mul_f32 v20, v42, v51
    v_mul_f32 v21, v44, v53
    v_cvt_pk_bf16_f32 v125, v20, v21
    v_mul_f32 v22, v46, v55
    v_mul_f32 v23, v48, v57
    v_cvt_pk_bf16_f32 v126, v22, v23
    v_mul_f32 v24, v50, v33
    v_mul_f32 v25, v52, v35
    v_cvt_pk_bf16_f32 v127, v24, v25
    v_mul_f32 v18, v54, v37
    v_mul_f32 v19, v56, v39
    v_cvt_pk_bf16_f32 v128, v18, v19
    v_mul_f32 v20, v32, v42
    v_mul_f32 v21, v34, v44
    v_cvt_pk_bf16_f32 v129, v20, v21
    v_mul_f32 v22, v36, v46
    v_mul_f32 v23, v38, v48
    v_cvt_pk_bf16_f32 v130, v22, v23
    v_mul_f32 v24, v40, v50
    v_mul_f32 v25, v42, v52
    v_cvt_pk_bf16_f32 v131, v24, v25
    v_mul_f32 v18, v44, v54
    v_mul_f32 v19, v46, v56
    v_cvt_pk_bf16_f32 v132, v18, v19
    v_mul_f32 v20, v48, v32
    v_mul_f32 v21, v50, v34
    v_cvt_pk_bf16_f32 v133, v20, v21
    v_mul_f32 v22, v52, v36
    v_mul_f32 v23, v54, v38
    v_cvt_pk_bf16_f32 v134, v22, v23
    v_mul_f32 v24, v56, v40
    v_mul_f32 v25, v32, v43
    v_cvt_pk_bf16_f32 v135, v24, v25
    v_mul_f32 v18, v34, v45
    v_mul_f32 v19, v36, v47
    v_cvt_pk_bf16_f32 v136, v18, v19
    v_mul_f32 v20, v38, v49
    v_mul_f32 v21, v40, v51
    v_cvt_pk_bf16_f32 v137, v20, v21
    v_mul_f32 v22, v42, v53
    v_mul_f32 v23, v44, v55
    v_cvt_pk_bf16_f32 v138, v22, v23
    v_mul_f32 v24, v46, v57
    v_mul_f32 v25, v48, v33
    v_cvt_pk_bf16_f32 v139, v24, v25
    v_mul_f32 v18, v50, v35
    v_mul_f32 v19, v52, v37
    v_cvt_pk_bf16_f32 v140, v18, v19
    v_mul_f32 v20, v54, v39
    v_mul_f32 v21, v56, v41
    v_cvt_pk_bf16_f32 v141, v20, v21
    v_mul_f32 v22, v32, v44
    v_mul_f32 v23, v34, v46
    v_cvt_pk_bf16_f32 v142, v22, v23
    v_mul_f32 v24, v36, v48
    v_mul_f32 v25, v38, v50
    v_cvt_pk_bf16_f32 v143, v24, v25
    v_mul_f32 v18, v40, v52
    v_mul_f32 v19, v42, v54
    v_cvt_pk_bf16_f32 v144, v18, v19
    v_mul_f32 v20, v44, v56
    v_mul_f32 v21, v46, v32
    v_cvt_pk_bf16_f32 v145, v20, v21
    v_mul_f32 v22, v48, v34
    v_mul_f32 v23, v50, v36
    v_cvt_pk_bf16_f32 v146, v22, v23
    v_mul_f32 v24, v52, v38
    v_mul_f32 v25, v54, v40
    v_cvt_pk_bf16_f32 v147, v24, v25
    v_mul_f32 v18, v56, v42
    v_mul_f32 v19, v32, v45
    v_cvt_pk_bf16_f32 v148, v18, v19
    v_mul_f32 v20, v34, v47
    v_mul_f32 v21, v36, v49
    v_cvt_pk_bf16_f32 v149, v20, v21
    v_mul_f32 v22, v38, v51
    v_mul_f32 v23, v40, v53
    v_cvt_pk_bf16_f32 v150, v22, v23
    v_mul_f32 v24, v42, v55
    v_mul_f32 v25, v44, v57
    v_cvt_pk_bf16_f32 v151, v24, v25
    v_cvt_pk_bf16_f32 v152, v32, v34
    v_cvt_pk_bf16_f32 v153, v36, v38
    v_cvt_pk_bf16_f32 v154, v40, v42
    v_cvt_pk_bf16_f32 v155, v44, v46
    v_cvt_pk_bf16_f32 v156, v48, v50
    v_cvt_pk_bf16_f32 v157, v52, v54
    v_cvt_pk_bf16_f32 v158, v56, 1.0
    v_mov_b32 v159, 0
    s_mov_b32 s54, 4096
    s_cmp_lg_u32 s3, 0
    s_cbranch_scc1 L_g3x
    v_mul_u32_u24 v18, 720, v0
    v_add_u32 v18, 708, v18
    v_mul_u32_u24 v19, 784, v0
    v_add_u32 v19, -892, v19
    v_cmp_gt_u32 vcc, 26, v0
    s_mov_b32 s88, -1
    s_mov_b32 s89, 0xfffff
    v_cndmask_b32 v18, v19, v18, vcc
    s_mov_b32 s86, 1024
L_g3:
    buffer_load_dword v237, v16, s[40:43], 0 offen sc1
    buffer_load_dword v19, v18, s[28:31], 0 offen sc1
    s_waitcnt vmcnt(0)
    v_cmp_ne_u32 vcc, v19, v237
    v_cmp_eq_u32 s[52:53], 0, v237
    s_or_b64 vcc, vcc, s[52:53]
    s_and_b64 vcc, vcc, s[88:89]
    s_cbranch_scc0 L_g3y
    s_sleep 8
    s_sub_u32 s86, s86, 1
    s_cbranch_scc0 L_g3
L_g3y:
    v_mov_b32 v1, 99
    ds_write_b32 v8, v1
L_g3x:
    s_cmp_lt_u32 s3, 4
    s_cbranch_scc1 L_notld1
L_pf1:
    ds_read_b128 v[20:23], v9 offset:0
    s_waitcnt lgkmcnt(0)
    v_min3_u32 v20, v20, v21, v22
    v_min_u32 v20, v20, v23
    v_cmp_gt_u32 vcc, 13, v20
    s_cbranch_vccz L_pf1x
    s_sleep 1
    s_sub_u32 s60, s60, 1
    s_cbranch_scc0 L_pf1
L_pf1x:
    s_mov_b32 m0, s57
    s_nop 0
    buffer_load_dwordx4 v13, s[28:31], s57 offen offset:0 sc1 lds
    buffer_load_dwordx4 v13, s[28:31], s57 offen offset:1024 sc1 lds
    buffer_load_dwordx4 v13, s[28:31], s57 offen offset:2048 sc1 lds
    buffer_load_dwordx4 v13, s[28:31], s57 offen offset:3072 sc1 lds
    s_mov_b32 m0, s58
    s_nop 0
    buffer_load_dwordx4 v13, s[28:31], s58 offen sc1 lds
    s_mov_b32 m0, s59
    s_nop 0
    buffer_load_dwordx4 v13, s[28:31], s59 offen offset:0 sc1 lds
    buffer_load_dwordx4 v13, s[28:31], s59 offen offset:1024 sc1 lds
    buffer_load_dwordx4 v13, s[28:31], s59 offen offset:2048 sc1 lds
    buffer_load_dwordx4 v13, s[28:31], s59 offen offset:3072 sc1 lds
    s_mov_b32 m0, s55
    s_nop 0
    buffer_load_dwordx4 v13, s[28:31], s55 offen sc1 lds
    s_waitcnt vmcnt(5)
    v_mov_b32 v1, 1
    ds_write_b32 v8, v1
L_notld1:
L_pg1:
    ds_read_b128 v[20:23], v9 offset:16
    s_waitcnt lgkmcnt(0)
    v_min3_u32 v20, v20, v21, v22
    v_min_u32 v20, v20, v23
    v_cmp_gt_u32 vcc, 1, v20
    s_cbranch_vccz L_pg1x
    s_sleep 1
    s_sub_u32 s60, s60, 1
    s_cbranch_scc0 L_pg1
L_pg1x:
L_redo:
    buffer_load_dword v237, v16, s[40:43], 0 offen sc1
    buffer_load_ushort v240, v17, s[32:35], 0 offen
    v_mov_b32 v24, 0
    v_mov_b32 v25, 0
    ds_read_b128 v[32:35], v11 offset:0
    ds_read_b128 v[36:39], v11 offset:32
    ds_read_b128 v[40:43], v11 offset:64
    ds_read_b128 v[44:47], v11 offset:96
    ds_read_b128 v[48:51], v11 offset:128
    ds_read_b128 v[52:55], v11 offset:160
    ds_read_b128 v[56:59], v11 offset:192
    ds_read_b128 v[60:63], v11 offset:224
    s_waitcnt lgkmcnt(7)
    v_mfma_f32_32x32x16_bf16 v[160:175], v[32:35], v[64:67], 0
    v_add3_u32 v24, v24, v32, v33
    v_add3_u32 v24, v24, v34, v35
    ds_read_b128 v[32:35], v11 offset:256
    s_waitcnt lgkmcnt(7)
    v_mfma_f32_32x32x16_bf16 v[160:175], v[36:39], v[68:71], v[160:175]
    v_add3_u32 v24, v24, v36, v37
    v_add3_u32 v24, v24, v38, v39
    ds_read_b128 v[36:39], v11 offset:288
    s_waitcnt lgkmcnt(7)
    v_mfma_f32_32x32x16_bf16 v[160:175], v[40:43], v[72:75], v[160:175]
    v_add3_u32 v24, v24, v40, v41
    v_add3_u32 v24, v24, v42, v43
    ds_read_b128 v[40:43], v11 offset:320
    s_waitcnt lgkmcnt(7)
    v_mfma_f32_32x32x16_bf16 v[160:175], v[44:47], v[76:79], v[160:175]
    v_add3_u32 v24, v24, v44, v45
    v_add3_u32 v24, v24, v46, v47
    ds_read_b128 v[44:47], v11 offset:352
    s_waitcnt lgkmcnt(7)
    v_mfma_f32_32x32x16_bf16 v[160:175], v[48:51], v[80:83], v[160:175]
    v_add3_u32 v24, v24, v48, v49
    v_add3_u32 v24, v24, v50, v51
    ds_read_b128 v[48:51], v11 offset:384
    s_waitcnt lgkmcnt(7)
    v_mfma_f32_32x32x16_bf16 v[160:175], v[52:55], v[84:87], v[160:175]
    v_add3_u32 v24, v24, v52, v53
    v_add3_u32 v24, v24, v54, v55
    ds_read_b128 v[52:55], v11 offset:416
    s_waitcnt lgkmcnt(7)
    v_mfma_f32_32x32x16_bf16 v[160:175], v[56:59], v[88:91], v[160:175]
    v_add3_u32 v24, v24, v56, v57
    v_add3_u32 v24, v24, v58, v59
    ds_read_b128 v[56:59], v11 offset:448
    s_waitcnt lgkmcnt(7)
    v_mfma_f32_32x32x16_bf16 v[160:175], v[60:63], v[92:95], v[160:175]
    v_add3_u32 v24, v24, v60, v61
    v_add3_u32 v24, v24, v62, v63
    ds_read_b128 v[60:63], v11 offset:480
    s_waitcnt lgkmcnt(7)
    v_mfma_f32_32x32x16_bf16 v[160:175], v[32:35], v[96:99], v[160:175]
    v_add3_u32 v24, v24, v32, v33
    v_add3_u32 v24, v24, v34, v35
    v_mov_b32 v1, 99
    s_cmp_lt_u32 s3, 4
    s_cbranch_scc1 L_nf2
    s_waitcnt vmcnt(2)
    v_mov_b32 v1, 2
L_nf2:
    ds_write_b32 v8, v1
    ds_read_b128 v[32:35], v11 offset:512
    s_waitcnt lgkmcnt(8)
    v_mfma_f32_32x32x16_bf16 v[160:175], v[36:39], v[100:103], v[160:175]
    v_add3_u32 v24, v24, v36, v37
    v_add3_u32 v24, v24, v38, v39
    ds_read_b128 v[36:39], v11 offset:544
    s_waitcnt lgkmcnt(8)
    v_mfma_f32_32x32x16_bf16 v[160:175], v[40:43], v[104:107], v[160:175]
    v_add3_u32 v24, v24, v40, v41
    v_add3_u32 v24, v24, v42, v43
    ds_read_b128 v[40:43], v11 offset:576
    s_waitcnt lgkmcnt(8)
    v_mfma_f32_32x32x16_bf16 v[160:175], v[44:47], v[108:111], v[160:175]
    v_add3_u32 v24, v24, v44, v45
    v_add3_u32 v24, v24, v46, v47
    ds_read_b128 v[20:23], v9 offset:16
    ds_read_b128 v[44:47], v11 offset:608
    s_waitcnt lgkmcnt(9)
    v_mfma_f32_32x32x16_bf16 v[160:175], v[48:51], v[112:115], v[160:175]
    v_add3_u32 v24, v24, v48, v49
    v_add3_u32 v24, v24, v50, v51
    ds_read_b128 v[48:51], v11 offset:640
    s_waitcnt lgkmcnt(9)
    v_mfma_f32_32x32x16_bf16 v[160:175], v[52:55], v[116:119], v[160:175]
    v_add3_u32 v24, v24, v52, v53
    v_add3_u32 v24, v24, v54, v55
    ds_read_b128 v[52:55], v11 offset:672
    s_waitcnt lgkmcnt(9)
    v_mfma_f32_32x32x16_bf16 v[160:175], v[56:59], v[120:123], v[160:175]
    v_add3_u32 v24, v24, v56, v57
    v_add3_u32 v24, v24, v58, v59
    s_waitcnt lgkmcnt(3)
    v_min3_u32 v20, v20, v21, v22
    v_min_u32 v20, v20, v23
    v_cmp_gt_u32 vcc, 2, v20
    s_cbranch_vccz L_pg2x
L_pg2:
    ds_read_b128 v[20:23], v9 offset:16
    s_waitcnt lgkmcnt(0)
    v_min3_u32 v20, v20, v21, v22
    v_min_u32 v20, v20, v23
    v_cmp_gt_u32 vcc, 2, v20
    s_cbranch_vccz L_pg2x
    s_sleep 1
    s_sub_u32 s60, s60, 1
    s_cbranch_scc0 L_pg2
L_pg2x:
    ds_read_b128 v[56:59], v12 offset:0
    s_waitcnt lgkmcnt(9)
    v_mfma_f32_32x32x16_bf16 v[160:175], v[60:63], v[124:127], v[160:175]
    v_add3_u32 v24, v24, v60, v61
    v_add3_u32 v24, v24, v62, v63
    ds_read_b128 v[60:63], v12 offset:32
    s_waitcnt lgkmcnt(8)
    v_mfma_f32_32x32x16_bf16 v[160:175], v[32:35], v[128:131], v[160:175]
    v_add3_u32 v24, v24, v32, v33
    v_add3_u32 v24, v24, v34, v35
    ds_read_b128 v[32:35], v12 offset:64
    s_waitcnt lgkmcnt(8)
    v_mfma_f32_32x32x16_bf16 v[160:175], v[36:39], v[132:135], v[160:175]
    v_add3_u32 v24, v24, v36, v37
    v_add3_u32 v24, v24, v38, v39
    ds_read_b128 v[36:39], v12 offset:96
    s_waitcnt lgkmcnt(8)
    v_mfma_f32_32x32x16_bf16 v[160:175], v[40:43], v[136:139], v[160:175]
    v_add3_u32 v24, v24, v40, v41
    v_add3_u32 v24, v24, v42, v43
    ds_read_b128 v[40:43], v12 offset:128
    s_waitcnt lgkmcnt(7)
    v_mfma_f32_32x32x16_bf16 v[160:175], v[44:47], v[140:143], v[160:175]
    v_add3_u32 v24, v24, v44, v45
    v_add3_u32 v24, v24, v46, v47
    ds_read_b128 v[44:47], v12 offset:160
    s_waitcnt lgkmcnt(7)
    v_mfma_f32_32x32x16_bf16 v[160:175], v[48:51], v[144:147], v[160:175]
    v_add3_u32 v24, v24, v48, v49
    v_add3_u32 v24, v24, v50, v51
    ds_read_b128 v[48:51], v12 offset:192
    s_waitcnt lgkmcnt(7)
    v_mfma_f32_32x32x16_bf16 v[160:175], v[52:55], v[148:151], v[160:175]
    v_add3_u32 v24, v24, v52, v53
    v_add3_u32 v24, v24, v54, v55
    ds_read_b128 v[52:55], v12 offset:224
    s_waitcnt lgkmcnt(7)
    v_mfma_f32_32x32x16_bf16 v[176:191], v[56:59], v[64:67], 0
    v_add3_u32 v25, v25, v56, v57
    v_add3_u32 v25, v25, v58, v59
    ds_read_b128 v[56:59], v12 offset:256
    s_waitcnt lgkmcnt(7)
    v_mfma_f32_32x32x16_bf16 v[176:191], v[60:63], v[68:71], v[176:191]
    v_add3_u32 v25, v25, v60, v61
    v_add3_u32 v25, v25, v62, v63
    ds_read_b128 v[60:63], v12 offset:288
    s_waitcnt lgkmcnt(7)
    v_mfma_f32_32x32x16_bf16 v[176:191], v[32:35], v[72:75], v[176:191]
    v_add3_u32 v25, v25, v32, v33
    v_add3_u32 v25, v25, v34, v35
    ds_read_b128 v[32:35], v12 offset:320
    s_waitcnt lgkmcnt(7)
    v_mfma_f32_32x32x16_bf16 v[176:191], v[36:39], v[76:79], v[176:191]
    v_add3_u32 v25, v25, v36, v37
    v_add3_u32 v25, v25, v38, v39
    ds_read_b128 v[36:39], v12 offset:352
    s_waitcnt lgkmcnt(7)
    v_mfma_f32_32x32x16_bf16 v[176:191], v[40:43], v[80:83], v[176:191]
    v_add3_u32 v25, v25, v40, v41
    v_add3_u32 v25, v25, v42, v43
    ds_read_b128 v[40:43], v12 offset:384
    s_waitcnt lgkmcnt(7)
    v_mfma_f32_32x32x16_bf16 v[176:191], v[44:47], v[84:87], v[176:191]
    v_add3_u32 v25, v25, v44, v45
    v_add3_u32 v25, v25, v46, v47
    ds_read_b128 v[44:47], v12 offset:416
    s_waitcnt lgkmcnt(7)
    v_mfma_f32_32x32x16_bf16 v[176:191], v[48:51], v[88:91], v[176:191]
    v_add3_u32 v25, v25, v48, v49
    v_add3_u32 v25, v25, v50, v51
    ds_read_b128 v[48:51], v12 offset:448
    s_waitcnt lgkmcnt(7)
    v_mfma_f32_32x32x16_bf16 v[176:191], v[52:55], v[92:95], v[176:191]
    v_add3_u32 v25, v25, v52, v53
    v_add3_u32 v25, v25, v54, v55
    ds_read_b128 v[52:55], v12 offset:480
    s_waitcnt lgkmcnt(7)
    v_mfma_f32_32x32x16_bf16 v[176:191], v[56:59], v[96:99], v[176:191]
    v_add3_u32 v25, v25, v56, v57
    v_add3_u32 v25, v25, v58, v59
    ds_read_b128 v[56:59], v12 offset:512
    s_waitcnt lgkmcnt(7)
    v_mfma_f32_32x32x16_bf16 v[176:191], v[60:63], v[100:103], v[176:191]
    v_add3_u32 v25, v25, v60, v61
    v_add3_u32 v25, v25, v62, v63
    ds_read_b128 v[60:63], v12 offset:544
    s_waitcnt lgkmcnt(7)
    v_mfma_f32_32x32x16_bf16 v[176:191], v[32:35], v[104:107], v[176:191]
    v_add3_u32 v25, v25, v32, v33
    v_add3_u32 v25, v25, v34, v35
    ds_read_b128 v[32:35], v12 offset:576
    s_waitcnt lgkmcnt(7)
    v_mfma_f32_32x32x16_bf16 v[176:191], v[36:39], v[108:111], v[176:191]
    v_add3_u32 v25, v25, v36, v37
    v_add3_u32 v25, v25, v38, v39
    ds_read_b128 v[36:39], v12 offset:608
    s_waitcnt lgkmcnt(7)
    v_mfma_f32_32x32x16_bf16 v[176:191], v[40:43], v[112:115], v[176:191]
    v_add3_u32 v25, v25, v40, v41
    v_add3_u32 v25, v25, v42, v43
    ds_read_b128 v[40:43], v12 offset:640
    s_waitcnt lgkmcnt(7)
    v_mfma_f32_32x32x16_bf16 v[176:191], v[44:47], v[116:119], v[176:191]
    v_add3_u32 v25, v25, v44, v45
    v_add3_u32 v25, v25, v46, v47
    ds_read_b128 v[44:47], v12 offset:672
    s_waitcnt lgkmcnt(7)
    v_mfma_f32_32x32x16_bf16 v[176:191], v[48:51], v[120:123], v[176:191]
    v_add3_u32 v25, v25, v48, v49
    v_add3_u32 v25, v25, v50, v51
    ds_read_b128 v[48:51], v12 offset:704
    s_waitcnt lgkmcnt(7)
    v_mfma_f32_32x32x16_bf16 v[176:191], v[52:55], v[124:127], v[176:191]
    v_add3_u32 v25, v25, v52, v53
    v_add3_u32 v25, v25, v54, v55
    ds_read_b128 v[52:55], v12 offset:736
    s_waitcnt lgkmcnt(7)
    v_mfma_f32_32x32x16_bf16 v[176:191], v[56:59], v[128:131], v[176:191]
    v_add3_u32 v25, v25, v56, v57
    v_add3_u32 v25, v25, v58, v59
    ds_read_b32 v18, v11 offset:704
    ds_read_b32 v19, v12 offset:768
    s_waitcnt lgkmcnt(8)
    v_mfma_f32_32x32x16_bf16 v[176:191], v[60:63], v[132:135], v[176:191]
    v_add3_u32 v25, v25, v60, v61
    v_add3_u32 v25, v25, v62, v63
    s_waitcnt lgkmcnt(7)
    v_mfma_f32_32x32x16_bf16 v[176:191], v[32:35], v[136:139], v[176:191]
    v_add3_u32 v25, v25, v32, v33
    v_add3_u32 v25, v25, v34, v35
    s_waitcnt lgkmcnt(6)
    v_mfma_f32_32x32x16_bf16 v[176:191], v[36:39], v[140:143], v[176:191]
    v_add3_u32 v25, v25, v36, v37
    v_add3_u32 v25, v25, v38, v39
    s_waitcnt lgkmcnt(5)
    v_mfma_f32_32x32x16_bf16 v[176:191], v[40:43], v[144:147], v[176:191]
    v_add3_u32 v25, v25, v40, v41
    v_add3_u32 v25, v25, v42, v43
    s_waitcnt lgkmcnt(4)
    v_mfma_f32_32x32x16_bf16 v[176:191], v[44:47], v[148:151], v[176:191]
    v_add3_u32 v25, v25, v44, v45
    v_add3_u32 v25, v25, v46, v47
    s_waitcnt lgkmcnt(3)
    v_mfma_f32_32x32x16_bf16 v[176:191], v[48:51], v[152:155], v[176:191]
    v_add3_u32 v25, v25, v48, v49
    v_add3_u32 v25, v25, v50, v51
    buffer_load_dwordx2 v[238:239], v14, s[48:51], s96 offen sc1
    s_waitcnt lgkmcnt(2)
    v_mfma_f32_32x32x16_bf16 v[176:191], v[52:55], v[156:159], v[176:191]
    v_add3_u32 v25, v25, v52, v53
    v_add3_u32 v25, v25, v54, v55
    v_mov_b32 v26, v24
    v_mov_b32 v27, v25
    s_waitcnt vmcnt(1) lgkmcnt(0)
    v_permlane32_swap_b32 v24, v26
    v_permlane32_swap_b32 v25, v27
    s_nop 1
    v_add3_u32 v24, v24, v26, v237
    v_add3_u32 v25, v25, v27, v237
    v_cmp_ne_u32 vcc, v24, v18
    v_cmp_ne_u32 s[52:53], v25, v19
    s_nop 3
    v_mul_f32 v24, v160, v176
    s_or_b32 s52, s52, vcc_lo
    s_and_b32 s52, s52, 0x11ffffff
    s_cbranch_scc1 L_slow
L_ckok:
    v_fma_f32 v24, v161, v177, v24
    v_fma_f32 v24, v162, v178, v24
    v_fma_f32 v24, v163, v179, v24
    v_fma_f32 v24, v164, v180, v24
    v_fma_f32 v24, v165, v181, v24
    v_fma_f32 v24, v166, v182, v24
    v_fma_f32 v24, v167, v183, v24
    v_fma_f32 v24, v168, v184, v24
    v_fma_f32 v24, v169, v185, v24
    v_fma_f32 v24, v170, v186, v24
    v_fma_f32 v24, v171, v187, v24
    v_fma_f32 v24, v172, v188, v24
    s_mov_b32 s54, 131072
L_fin:
    s_waitcnt vmcnt(0)
    v_cmp_ne_u32 vcc, v239, v237
    s_and_b32 s52, vcc_lo, s99
    s_cbranch_scc0 L_finok

    s_sub_u32 s54, s54, 1
    s_cbranch_scc1 L_finok
    buffer_load_dwordx2 v[238:239], v14, s[48:51], s96 offen sc1
    s_branch L_fin
L_finok:
    v_add_f32 v24, v24, v238
    s_nop 1
    v_add_f32_dpp v24, v24, v24 row_shr:1 row_mask:0xf bank_mask:0xf bound_ctrl:0
    s_nop 1
    v_add_f32_dpp v24, v24, v24 row_shr:2 row_mask:0xf bank_mask:0xf bound_ctrl:0
    s_nop 1
    v_add_f32_dpp v24, v24, v24 row_shr:4 row_mask:0xf bank_mask:0xf bound_ctrl:0
    s_nop 1
    v_add_f32_dpp v24, v24, v24 row_shr:8 row_mask:0xf bank_mask:0xf bound_ctrl:0
    s_nop 1
    v_add_f32_dpp v24, v24, v24 row_bcast:15 row_mask:0xa bank_mask:0xf
    s_nop 1
    v_add_f32_dpp v24, v24, v24 row_bcast:31 row_mask:0xc bank_mask:0xf
    v_lshlrev_b32 v240, 16, v240
    v_add_f32 v24, v24, v240
    v_cvt_pk_bf16_f32 v24, v24, v24
    s_mov_b32 exec_lo, 0
    s_mov_b32 exec_hi, 0x80000000
    buffer_store_short v24, v17, s[44:47], 0 offen
    s_endpgm
L_slow:
    s_sub_u32 s54, s54, 1
    s_cbranch_scc1 L_ckok
    s_sleep 8
    s_mov_b32 s52, 0
L_sl1:
    s_mov_b32 m0, s52
    s_nop 0
    buffer_load_dwordx4 v13, s[28:31], s52 offen sc1 lds
    s_add_u32 s52, s52, 1024
    s_cmp_lt_u32 s52, 39936
    s_cbranch_scc1 L_sl1
    s_waitcnt vmcnt(0)
    s_branch L_redo
L_prod:
    s_and_b32 s52, s3, 1
    s_lshl_b32 s26, s2, 1
    s_add_u32 s26, s26, s52
    v_lshlrev_b32 v13, 4, v0
    s_lshl_b32 s56, s3, 10
    v_add_u32 v12, s56, v13
    v_mov_b32 v71, 208
    s_waitcnt lgkmcnt(0)
    s_add_u32 s28, s8, 70304
    s_addc_u32 s29, s9, 0
    s_mov_b32 s30, 35152
    s_mov_b32 s31, 0x20000
    s_load_dwordx8 s[84:91], s[10:11], 104
    s_load_dwordx4 s[92:95], s[10:11], 136
    s_load_dword s96, s[10:11], 152
    s_lshr_b32 s52, s26, 1
    s_lshl_b32 s52, s52, 2
    s_load_dword s97, s[10:11], s52
    s_mov_b32 s40, s22
    s_mov_b32 s41, s23
    s_mov_b32 s42, 256
    s_mov_b32 s43, 0x20000
    s_cmp_lt_u32 s3, 6
    s_cbranch_scc1 L_p_noA1ld
    s_mul_i32 s52, s26, 1352
    s_add_u32 s32, s8, s52
    s_addc_u32 s33, s9, 0
    s_mov_b32 s34, 1352
    s_mov_b32 s35, 0x20000
    s_and_b32 s52, s3, 1
    s_lshl_b32 s52, s52, 11
    s_add_u32 s57, s52, 40960
    s_mov_b32 m0, s57
    s_nop 0
    buffer_load_dwordx4 v13, s[32:35], 0 offen lds
    buffer_load_dwordx4 v13, s[32:35], 0 offen offset:1024 lds
L_p_noA1ld:
    s_and_b32 s52, s3, 6
    s_cmp_lg_u32 s52, 0
    s_cbranch_scc1 L_p_noQld
    s_mul_i32 s52, s26, 52
    s_sub_u32 s53, 35152, s52
    s_add_u32 s52, s52, 35152
    s_add_u32 s32, s8, s52
    s_addc_u32 s33, s9, 0
    s_mov_b32 s34, s53
    s_mov_b32 s35, 0x20000
    v_and_b32 v1, 31, v0
    v_lshrrev_b32 v2, 5, v0
    v_mul_u32_u24 v3, 10816, v2
    v_lshl_add_u32 v3, v1, 1, v3
    v_mov_b32 v4, 0x100000
    v_cmp_gt_u32 vcc, 26, v1
    s_nop 1
    v_cndmask_b32 v3, v4, v3, vcc
    v_add_u32 v4, 5408, v3
    v_add_u32 v5, 21632, v3
    v_add_u32 v6, 27040, v3
    buffer_load_ushort v32, v3, s[32:35], 0 offen offset:0
    buffer_load_ushort v128, v3, s[32:35], 0 offen offset:1352
    buffer_load_ushort v33, v3, s[32:35], 0 offen offset:2704
    buffer_load_ushort v129, v3, s[32:35], 0 offen offset:4056
    buffer_load_ushort v34, v4, s[32:35], 0 offen offset:0
    buffer_load_ushort v130, v4, s[32:35], 0 offen offset:1352
    buffer_load_ushort v35, v4, s[32:35], 0 offen offset:2704
    buffer_load_ushort v131, v4, s[32:35], 0 offen offset:4056
    buffer_load_ushort v36, v5, s[32:35], 0 offen offset:0
    buffer_load_ushort v132, v5, s[32:35], 0 offen offset:1352
    buffer_load_ushort v37, v5, s[32:35], 0 offen offset:2704
    buffer_load_ushort v133, v5, s[32:35], 0 offen offset:4056
    buffer_load_ushort v38, v6, s[32:35], 0 offen offset:0
    buffer_load_ushort v134, v6, s[32:35], 0 offen offset:1352
    buffer_load_ushort v39, v6, s[32:35], 0 offen offset:2704
    buffer_load_ushort v135, v6, s[32:35], 0 offen offset:4056
L_p_noQld:
    s_add_u32 m0, s56, 0
    v_add_u32 v26, 0, v12
    buffer_load_dwordx4 v26, s[28:31], 0 offen lds
    s_add_u32 m0, s56, 8192
    v_add_u32 v27, 8192, v12
    buffer_load_dwordx4 v27, s[28:31], 0 offen lds
    s_add_u32 m0, s56, 16384
    v_add_u32 v28, 16384, v12
    buffer_load_dwordx4 v28, s[28:31], 0 offen lds
    s_add_u32 m0, s56, 24576
    v_add_u32 v29, 24576, v12
    buffer_load_dwordx4 v29, s[28:31], 0 offen lds
    s_cmp_ge_u32 s3, 3
    s_cbranch_scc1 L_p_w3done
    s_add_u32 m0, s56, 32768
    v_add_u32 v30, 32768, v12
    buffer_load_dwordx4 v30, s[28:31], 0 offen lds
L_p_w3done:
    s_cmp_lg_u32 s2, 0
    s_cbranch_scc1 L_p_nonon
    s_cmp_lg_u32 s3, 5
    s_cbranch_scc1 L_p_nonon
    s_memrealtime s[98:99]
    s_waitcnt lgkmcnt(0)
    s_or_b32 s98, s98, 1
    v_mov_b32 v1, s98
    v_mov_b32 v2, 208
    s_mov_b64 exec, 1
    buffer_store_dword v1, v2, s[40:43], 0 offen sc1
    s_mov_b64 exec, -1
L_p_nonon:
    s_cmp_lg_u32 s3, 4
    s_cbranch_scc1 L_p_noET
    s_add_u32 s32, s10, 52
    s_addc_u32 s33, s11, 0
    s_mov_b32 s34, 52
    s_mov_b32 s35, 0x20000
    v_lshlrev_b32 v1, 2, v0
    buffer_load_dword v2, v1, s[32:35], 0 offen
    v_mov_b32 v4, 0
    v_mov_b32 v5, 0
    v_mov_b32 v6, 0
    v_mov_b32 v7, 0
    v_add_u32 v3, 36864, v13
    ds_write_b128 v3, v[4:7]
    ds_write_b128 v3, v[4:7] offset:1024
    ds_write_b128 v3, v[4:7] offset:2048
    v_add_u32 v1, 38944, v1
    s_mov_b32 s52, 0x3f80
    s_waitcnt vmcnt(0)
    v_writelane_b32 v2, s52, 13
    s_mov_b64 exec, 0x3fff
    ds_write_b32 v1, v2
    s_mov_b64 exec, -1
L_p_noET:
    s_add_u32 s52, s3, 2
    s_and_b32 s52, s52, 4
    s_cbranch_scc1 L_p_noidx
    s_and_b32 s52, s3, 1
    s_cmp_lt_u32 s3, 4
    s_cbranch_scc1 L_p_isQ
    s_mov_b32 s58, 52
    s_mov_b32 s59, 1
    s_add_u32 s27, s57, 2040
    s_branch L_p_idx
L_p_isQ:
    s_mul_i32 s57, s52, 4608
    s_add_u32 s57, s57, 45056
    s_mov_b32 s58, 132
    s_mov_b32 s59, 2
    s_add_u32 s27, s57, 3556
L_p_idx:
    v_lshrrev_b32 v1, 1, v0
    v_lshlrev_b32 v1, 3, v1
    v_and_b32 v2, 1, v0
    v_mov_b32 v10, s27
    v_mov_b32 v11, 0
    ds_write_b32 v10, v11
    v_add_u32 v14, 0, v1
    v_mul_u32_u24 v15, 5042, v14
    v_lshrrev_b32 v15, 16, v15
    v_mul_u32_u24 v16, 13, v15
    v_sub_u32 v16, v14, v16
    v_lshl_add_u32 v16, v16, 1, v2
    v_add_u32 v17, v16, v15
    v_subrev_u32 v18, 26, v17
    v_min_u32 v17, v17, v18
    v_lshlrev_b32 v18, s59, v17
    v_mad_u32_u24 v40, v16, s58, v18
    v_lshlrev_b32 v18, s59, v16
    v_mad_u32_u24 v48, v17, s58, v18
    v_cmp_lt_u32 vcc, 175, v14
    v_cmp_eq_u32 s[52:53], 0, v15
    v_subrev_u32 v18, 176, v14
    v_lshl_add_u32 v18, v18, 1, v2
    v_lshlrev_b32 v18, 2, v18
    v_add_u32 v18, 3432, v18
    v_cndmask_b32 v40, v40, v18, vcc
    v_add_u32 v40, s57, v40
    v_add_u32 v48, s57, v48
    v_cndmask_b32 v48, v48, v10, vcc
    v_cndmask_b32 v48, v48, v10, s[52:53]
    v_add_u32 v14, 1, v1
    v_mul_u32_u24 v15, 5042, v14
    v_lshrrev_b32 v15, 16, v15
    v_mul_u32_u24 v16, 13, v15
    v_sub_u32 v16, v14, v16
    v_lshl_add_u32 v16, v16, 1, v2
    v_add_u32 v17, v16, v15
    v_subrev_u32 v18, 26, v17
    v_min_u32 v17, v17, v18
    v_lshlrev_b32 v18, s59, v17
    v_mad_u32_u24 v41, v16, s58, v18
    v_lshlrev_b32 v18, s59, v16
    v_mad_u32_u24 v49, v17, s58, v18
    v_cmp_lt_u32 vcc, 175, v14
    v_cmp_eq_u32 s[52:53], 0, v15
    v_subrev_u32 v18, 176, v14
    v_lshl_add_u32 v18, v18, 1, v2
    v_lshlrev_b32 v18, 2, v18
    v_add_u32 v18, 3432, v18
    v_cndmask_b32 v41, v41, v18, vcc
    v_add_u32 v41, s57, v41
    v_add_u32 v49, s57, v49
    v_cndmask_b32 v49, v49, v10, vcc
    v_cndmask_b32 v49, v49, v10, s[52:53]
    v_add_u32 v14, 2, v1
    v_mul_u32_u24 v15, 5042, v14
    v_lshrrev_b32 v15, 16, v15
    v_mul_u32_u24 v16, 13, v15
    v_sub_u32 v16, v14, v16
    v_lshl_add_u32 v16, v16, 1, v2
    v_add_u32 v17, v16, v15
    v_subrev_u32 v18, 26, v17
    v_min_u32 v17, v17, v18
    v_lshlrev_b32 v18, s59, v17
    v_mad_u32_u24 v42, v16, s58, v18
    v_lshlrev_b32 v18, s59, v16
    v_mad_u32_u24 v50, v17, s58, v18
    v_cmp_lt_u32 vcc, 175, v14
    v_cmp_eq_u32 s[52:53], 0, v15
    v_subrev_u32 v18, 176, v14
    v_lshl_add_u32 v18, v18, 1, v2
    v_lshlrev_b32 v18, 2, v18
    v_add_u32 v18, 3432, v18
    v_cndmask_b32 v42, v42, v18, vcc
    v_add_u32 v42, s57, v42
    v_add_u32 v50, s57, v50
    v_cndmask_b32 v50, v50, v10, vcc
    v_cndmask_b32 v50, v50, v10, s[52:53]
    v_add_u32 v14, 3, v1
    v_mul_u32_u24 v15, 5042, v14
    v_lshrrev_b32 v15, 16, v15
    v_mul_u32_u24 v16, 13, v15
    v_sub_u32 v16, v14, v16
    v_lshl_add_u32 v16, v16, 1, v2
    v_add_u32 v17, v16, v15
    v_subrev_u32 v18, 26, v17
    v_min_u32 v17, v17, v18
    v_lshlrev_b32 v18, s59, v17
    v_mad_u32_u24 v43, v16, s58, v18
    v_lshlrev_b32 v18, s59, v16
    v_mad_u32_u24 v51, v17, s58, v18
    v_cmp_lt_u32 vcc, 175, v14
    v_cmp_eq_u32 s[52:53], 0, v15
    v_subrev_u32 v18, 176, v14
    v_lshl_add_u32 v18, v18, 1, v2
    v_lshlrev_b32 v18, 2, v18
    v_add_u32 v18, 3432, v18
    v_cndmask_b32 v43, v43, v18, vcc
    v_add_u32 v43, s57, v43
    v_add_u32 v51, s57, v51
    v_cndmask_b32 v51, v51, v10, vcc
    v_cndmask_b32 v51, v51, v10, s[52:53]
    v_add_u32 v14, 4, v1
    v_mul_u32_u24 v15, 5042, v14
    v_lshrrev_b32 v15, 16, v15
    v_mul_u32_u24 v16, 13, v15
    v_sub_u32 v16, v14, v16
    v_lshl_add_u32 v16, v16, 1, v2
    v_add_u32 v17, v16, v15
    v_subrev_u32 v18, 26, v17
    v_min_u32 v17, v17, v18
    v_lshlrev_b32 v18, s59, v17
    v_mad_u32_u24 v44, v16, s58, v18
    v_lshlrev_b32 v18, s59, v16
    v_mad_u32_u24 v52, v17, s58, v18
    v_cmp_lt_u32 vcc, 175, v14
    v_cmp_eq_u32 s[52:53], 0, v15
    v_subrev_u32 v18, 176, v14
    v_lshl_add_u32 v18, v18, 1, v2
    v_lshlrev_b32 v18, 2, v18
    v_add_u32 v18, 3432, v18
    v_cndmask_b32 v44, v44, v18, vcc
    v_add_u32 v44, s57, v44
    v_add_u32 v52, s57, v52
    v_cndmask_b32 v52, v52, v10, vcc
    v_cndmask_b32 v52, v52, v10, s[52:53]
    v_add_u32 v14, 5, v1
    v_mul_u32_u24 v15, 5042, v14
    v_lshrrev_b32 v15, 16, v15
    v_mul_u32_u24 v16, 13, v15
    v_sub_u32 v16, v14, v16
    v_lshl_add_u32 v16, v16, 1, v2
    v_add_u32 v17, v16, v15
    v_subrev_u32 v18, 26, v17
    v_min_u32 v17, v17, v18
    v_lshlrev_b32 v18, s59, v17
    v_mad_u32_u24 v45, v16, s58, v18
    v_lshlrev_b32 v18, s59, v16
    v_mad_u32_u24 v53, v17, s58, v18
    v_cmp_lt_u32 vcc, 175, v14
    v_cmp_eq_u32 s[52:53], 0, v15
    v_subrev_u32 v18, 176, v14
    v_lshl_add_u32 v18, v18, 1, v2
    v_lshlrev_b32 v18, 2, v18
    v_add_u32 v18, 3432, v18
    v_cndmask_b32 v45, v45, v18, vcc
    v_add_u32 v45, s57, v45
    v_add_u32 v53, s57, v53
    v_cndmask_b32 v53, v53, v10, vcc
    v_cndmask_b32 v53, v53, v10, s[52:53]
    v_add_u32 v14, 6, v1
    v_mul_u32_u24 v15, 5042, v14
    v_lshrrev_b32 v15, 16, v15
    v_mul_u32_u24 v16, 13, v15
    v_sub_u32 v16, v14, v16
    v_lshl_add_u32 v16, v16, 1, v2
    v_add_u32 v17, v16, v15
    v_subrev_u32 v18, 26, v17
    v_min_u32 v17, v17, v18
    v_lshlrev_b32 v18, s59, v17
    v_mad_u32_u24 v46, v16, s58, v18
    v_lshlrev_b32 v18, s59, v16
    v_mad_u32_u24 v54, v17, s58, v18
    v_cmp_lt_u32 vcc, 175, v14
    v_cmp_eq_u32 s[52:53], 0, v15
    v_subrev_u32 v18, 176, v14
    v_lshl_add_u32 v18, v18, 1, v2
    v_lshlrev_b32 v18, 2, v18
    v_add_u32 v18, 3432, v18
    v_cndmask_b32 v46, v46, v18, vcc
    v_add_u32 v46, s57, v46
    v_add_u32 v54, s57, v54
    v_cndmask_b32 v54, v54, v10, vcc
    v_cndmask_b32 v54, v54, v10, s[52:53]
    v_add_u32 v14, 7, v1
    v_mul_u32_u24 v15, 5042, v14
    v_lshrrev_b32 v15, 16, v15
    v_mul_u32_u24 v16, 13, v15
    v_sub_u32 v16, v14, v16
    v_lshl_add_u32 v16, v16, 1, v2
    v_add_u32 v17, v16, v15
    v_subrev_u32 v18, 26, v17
    v_min_u32 v17, v17, v18
    v_lshlrev_b32 v18, s59, v17
    v_mad_u32_u24 v47, v16, s58, v18
    v_lshlrev_b32 v18, s59, v16
    v_mad_u32_u24 v55, v17, s58, v18
    v_cmp_lt_u32 vcc, 175, v14
    v_cmp_eq_u32 s[52:53], 0, v15
    v_subrev_u32 v18, 176, v14
    v_lshl_add_u32 v18, v18, 1, v2
    v_lshlrev_b32 v18, 2, v18
    v_add_u32 v18, 3432, v18
    v_cndmask_b32 v47, v47, v18, vcc
    v_add_u32 v47, s57, v47
    v_add_u32 v55, s57, v55
    v_cndmask_b32 v55, v55, v10, vcc
    v_cndmask_b32 v55, v55, v10, s[52:53]
    v_cmp_eq_u32 vcc, 43, v0
    s_nop 1
    v_cndmask_b32 v47, v47, v10, vcc
    v_cndmask_b32 v55, v55, v10, vcc
    buffer_load_dword v70, v71, s[40:43], 0 offen sc1
L_p_noidx:
    s_cmp_lt_u32 s3, 6
    s_cbranch_scc1 L_p_noA1
    v_mov_b32 v72, 0
    v_mov_b32 v73, 0
    v_mov_b32 v74, 0
    v_mov_b32 v75, 0
    v_mov_b32 v76, 0
    v_mov_b32 v77, 0
    v_mov_b32 v78, 0
    v_mov_b32 v79, 0
    v_mov_b32 v80, 0
    v_mov_b32 v81, 0
    v_mov_b32 v82, 0
    v_mov_b32 v83, 0
    v_mov_b32 v84, 0
    v_mov_b32 v85, 0
    v_mov_b32 v86, 0
    v_mov_b32 v87, 0
    s_waitcnt vmcnt(0) lgkmcnt(0)
    s_barrier
    buffer_load_dword v70, v71, s[40:43], 0 offen sc1
    ds_read_u16_d16_hi v72, v40
    ds_read_u16_d16_hi v80, v48
    ds_read_u16_d16_hi v73, v41
    ds_read_u16_d16_hi v81, v49
    ds_read_u16_d16_hi v74, v42
    ds_read_u16_d16_hi v82, v50
    ds_read_u16_d16_hi v75, v43
    ds_read_u16_d16_hi v83, v51
    ds_read_u16_d16_hi v76, v44
    ds_read_u16_d16_hi v84, v52
    ds_read_u16_d16_hi v77, v45
    ds_read_u16_d16_hi v85, v53
    ds_read_u16_d16_hi v78, v46
    ds_read_u16_d16_hi v86, v54
    ds_read_u16_d16_hi v79, v47
    ds_read_u16_d16_hi v87, v55
    s_waitcnt lgkmcnt(0)
    v_add_f32 v56, v72, v80
    v_add_f32 v57, v73, v81
    v_add_f32 v58, v74, v82
    v_add_f32 v59, v75, v83
    v_add_f32 v60, v76, v84
    v_add_f32 v61, v77, v85
    v_add_f32 v62, v78, v86
    v_add_f32 v63, v79, v87
    v_cvt_pk_bf16_f32 v64, v56, v57
    v_cvt_pk_bf16_f32 v65, v58, v59
    v_cvt_pk_bf16_f32 v66, v60, v61
    v_cvt_pk_bf16_f32 v67, v62, v63
    v_cmp_gt_u32 vcc, 44, v0
    s_nop 1
    v_cndmask_b32 v64, 0, v64, vcc
    v_cndmask_b32 v65, 0, v65, vcc
    v_cndmask_b32 v66, 0, v66, vcc
    v_cndmask_b32 v67, 0, v67, vcc
    s_mul_i32 s52, s26, 720
    s_add_u32 s52, s52, 0
    s_add_u32 s32, s24, s52
    s_addc_u32 s33, s25, 0
    s_mov_b32 s34, 720
    s_mov_b32 s35, 0x20000
    v_add3_u32 v68, v64, v65, v66
    v_add_u32 v68, v68, v67
    s_nop 1
    v_add_u32_dpp v68, v68, v68 row_shr:1 row_mask:0xf bank_mask:0xf bound_ctrl:0
    s_nop 1
    v_add_u32_dpp v68, v68, v68 row_shr:2 row_mask:0xf bank_mask:0xf bound_ctrl:0
    s_nop 1
    v_add_u32_dpp v68, v68, v68 row_shr:4 row_mask:0xf bank_mask:0xf bound_ctrl:0
    s_nop 1
    v_add_u32_dpp v68, v68, v68 row_shr:8 row_mask:0xf bank_mask:0xf bound_ctrl:0
    s_nop 1
    v_add_u32_dpp v68, v68, v68 row_bcast:15 row_mask:0xa bank_mask:0xf
    s_nop 1
    v_add_u32_dpp v68, v68, v68 row_bcast:31 row_mask:0xc bank_mask:0xf
    s_mov_b32 s53, 131072
    s_waitcnt vmcnt(0)
L_pn44:
    v_readfirstlane_b32 s27, v70
    s_cmp_lg_u32 s27, 0
    s_cbranch_scc1 L_pn44x
    buffer_load_dword v70, v71, s[40:43], 0 offen sc1
    s_sub_u32 s53, s53, 1
    s_waitcnt vmcnt(0)
    s_cbranch_scc0 L_pn44
L_pn44x:
    v_readlane_b32 s52, v68, 63
    s_add_u32 s52, s52, s27
    v_writelane_b32 v65, s27, 44
    v_writelane_b32 v64, s52, 44
    s_nop 1
    buffer_store_dwordx4 v[64:67], v13, s[32:35], 0 offen sc1
    s_branch L_p_noE
L_p_noA1:
    s_lshl_b32 s52, s3, 6
    v_add_u32 v1, s52, v0
    v_lshlrev_b32 v20, 2, v1
    v_mul_u32_u24 v2, 5042, v1
    v_lshrrev_b32 v2, 16, v2
    v_mul_u32_u24 v21, 13, v2
    v_sub_u32 v21, v1, v21
    v_mul_u32_u24 v21, 160, v21
    v_lshl_add_u32 v21, v2, 1, v21
    v_add_u32 v21, 36864, v21
    s_waitcnt vmcnt(0) lgkmcnt(0)
    s_barrier
    buffer_load_dword v70, v71, s[40:43], 0 offen sc1
    s_cmp_ge_u32 s3, 6
    s_cbranch_scc1 L_p_noE
    ds_read_b32 v96, v20 offset:0
    ds_read_b32 v97, v20 offset:1352
    ds_read_b32 v98, v20 offset:2704
    ds_read_b32 v99, v20 offset:4056
    ds_read_b32 v100, v20 offset:5408
    ds_read_b32 v101, v20 offset:6760
    ds_read_b32 v102, v20 offset:8112
    ds_read_b32 v103, v20 offset:9464
    ds_read_b32 v104, v20 offset:10816
    ds_read_b32 v105, v20 offset:12168
    ds_read_b32 v106, v20 offset:13520
    ds_read_b32 v107, v20 offset:14872
    ds_read_b32 v108, v20 offset:16224
    ds_read_b32 v109, v20 offset:17576
    s_mov_b32 s52, 0x05040100
    s_mov_b32 s53, 0x07060302
    v_mov_b32 v22, 0
    v_mov_b32 v23, 0
    s_waitcnt lgkmcnt(12)
    ds_read_b32 v110, v20 offset:18928
    ds_read_b32 v111, v20 offset:20280
    v_perm_b32 v24, v97, v96, s52
    v_perm_b32 v25, v97, v96, s53
    v_dot2_f32_bf16 v22, v24, s84, v22
    v_dot2_f32_bf16 v23, v25, s84, v23
    s_waitcnt lgkmcnt(12)
    ds_read_b32 v112, v20 offset:21632
    ds_read_b32 v113, v20 offset:22984
    v_perm_b32 v24, v99, v98, s52
    v_perm_b32 v25, v99, v98, s53
    v_dot2_f32_bf16 v22, v24, s85, v22
    v_dot2_f32_bf16 v23, v25, s85, v23
    s_waitcnt lgkmcnt(12)
    ds_read_b32 v114, v20 offset:24336
    ds_read_b32 v115, v20 offset:25688
    v_perm_b32 v24, v101, v100, s52
    v_perm_b32 v25, v101, v100, s53
    v_dot2_f32_bf16 v22, v24, s86, v22
    v_dot2_f32_bf16 v23, v25, s86, v23
    s_waitcnt lgkmcnt(12)
    ds_read_b32 v116, v20 offset:27040
    ds_read_b32 v117, v20 offset:28392
    v_perm_b32 v24, v103, v102, s52
    v_perm_b32 v25, v103, v102, s53
    v_dot2_f32_bf16 v22, v24, s87, v22
    v_dot2_f32_bf16 v23, v25, s87, v23
    s_waitcnt lgkmcnt(12)
    ds_read_b32 v118, v20 offset:29744
    ds_read_b32 v119, v20 offset:31096
    v_perm_b32 v24, v105, v104, s52
    v_perm_b32 v25, v105, v104, s53
    v_dot2_f32_bf16 v22, v24, s88, v22
    v_dot2_f32_bf16 v23, v25, s88, v23
    s_waitcnt lgkmcnt(12)
    ds_read_b32 v120, v20 offset:32448
    ds_read_b32 v121, v20 offset:33800
    v_perm_b32 v24, v107, v106, s52
    v_perm_b32 v25, v107, v106, s53
    v_dot2_f32_bf16 v22, v24, s89, v22
    v_dot2_f32_bf16 v23, v25, s89, v23
    s_waitcnt lgkmcnt(12)
    v_perm_b32 v24, v109, v108, s52
    v_perm_b32 v25, v109, v108, s53
    v_dot2_f32_bf16 v22, v24, s90, v22
    v_dot2_f32_bf16 v23, v25, s90, v23
    s_waitcnt lgkmcnt(10)
    v_perm_b32 v24, v111, v110, s52
    v_perm_b32 v25, v111, v110, s53
    v_dot2_f32_bf16 v22, v24, s91, v22
    v_dot2_f32_bf16 v23, v25, s91, v23
    s_waitcnt lgkmcnt(8)
    v_perm_b32 v24, v113, v112, s52
    v_perm_b32 v25, v113, v112, s53
    v_dot2_f32_bf16 v22, v24, s92, v22
    v_dot2_f32_bf16 v23, v25, s92, v23
    s_waitcnt lgkmcnt(6)
    v_perm_b32 v24, v115, v114, s52
    v_perm_b32 v25, v115, v114, s53
    v_dot2_f32_bf16 v22, v24, s93, v22
    v_dot2_f32_bf16 v23, v25, s93, v23
    s_waitcnt lgkmcnt(4)
    v_perm_b32 v24, v117, v116, s52
    v_perm_b32 v25, v117, v116, s53
    v_dot2_f32_bf16 v22, v24, s94, v22
    v_dot2_f32_bf16 v23, v25, s94, v23
    s_waitcnt lgkmcnt(2)
    v_perm_b32 v24, v119, v118, s52
    v_perm_b32 v25, v119, v118, s53
    v_dot2_f32_bf16 v22, v24, s95, v22
    v_dot2_f32_bf16 v23, v25, s95, v23
    s_waitcnt lgkmcnt(0)
    v_perm_b32 v24, v121, v120, s52
    v_perm_b32 v25, v121, v120, s53
    v_dot2_f32_bf16 v22, v24, s96, v22
    v_dot2_f32_bf16 v23, v25, s96, v23
    s_nop 2
    v_cvt_pk_bf16_f32 v22, v22, v23
    v_cmp_gt_u32 vcc, 338, v1
    s_and_saveexec_b64 s[52:53], vcc
    ds_write_b16 v21, v22
    ds_write_b16_d16_hi v21, v22 offset:80
    s_mov_b64 exec, -1
L_p_noE:
    s_waitcnt lgkmcnt(0)
    s_barrier
    s_and_b32 s52, s3, 6
    s_cmp_lg_u32 s52, 0
    s_cbranch_scc1 L_p_end
    v_and_b32 v1, 31, v0
    v_lshrrev_b32 v2, 5, v0
    v_mul_u32_u24 v3, 80, v1
    v_lshl_add_u32 v3, v2, 4, v3
    v_add_u32 v3, 36864, v3
    ds_read_b128 v[96:99], v3
    ds_read_b128 v[100:103], v3 offset:32
    v_lshl_or_b32 v32, v128, 16, v32
    v_lshl_or_b32 v33, v129, 16, v33
    v_lshl_or_b32 v34, v130, 16, v34
    v_lshl_or_b32 v35, v131, 16, v35
    v_lshl_or_b32 v36, v132, 16, v36
    v_lshl_or_b32 v37, v133, 16, v37
    v_lshl_or_b32 v38, v134, 16, v38
    v_lshl_or_b32 v39, v135, 16, v39
    s_and_b32 s52, s26, 1
    s_lshl_b32 s52, s52, 4
    s_lshr_b32 s97, s97, s52
    s_and_b32 s97, s97, 0xffff
    v_writelane_b32 v37, s97, 58
    v_mul_u32_u24 v4, 528, v2
    v_lshl_add_u32 v4, v1, 2, v4
    v_add_u32 v4, s57, v4
    s_waitcnt lgkmcnt(0)
    v_mfma_f32_32x32x16_bf16 v[104:119], v[96:99], v[32:35], 0
    v_mfma_f32_32x32x16_bf16 v[104:119], v[100:103], v[36:39], v[104:119]
    s_nop 7
    s_nop 3
    ds_write_b32 v4, v104 offset:0
    ds_write_b32 v4, v105 offset:132
    ds_write_b32 v4, v106 offset:264
    ds_write_b32 v4, v107 offset:396
    ds_write_b32 v4, v108 offset:1056
    ds_write_b32 v4, v109 offset:1188
    ds_write_b32 v4, v110 offset:1320
    ds_write_b32 v4, v111 offset:1452
    ds_write_b32 v4, v112 offset:2112
    ds_write_b32 v4, v113 offset:2244
    ds_write_b32 v4, v114 offset:2376
    ds_write_b32 v4, v115 offset:2508
    ds_write_b32 v4, v116 offset:3168
    ds_write_b32 v4, v117 offset:3300
    ds_write_b32 v4, v118 offset:3432
    ds_write_b32 v4, v119 offset:3564
    ds_read_b32 v72, v40
    ds_read_b32 v80, v48
    ds_read_b32 v73, v41
    ds_read_b32 v81, v49
    ds_read_b32 v74, v42
    ds_read_b32 v82, v50
    ds_read_b32 v75, v43
    ds_read_b32 v83, v51
    ds_read_b32 v76, v44
    ds_read_b32 v84, v52
    ds_read_b32 v77, v45
    ds_read_b32 v85, v53
    ds_read_b32 v78, v46
    ds_read_b32 v86, v54
    ds_read_b32 v79, v47
    ds_read_b32 v87, v55
    s_waitcnt lgkmcnt(0)
    v_add_f32 v56, v72, v80
    v_add_f32 v57, v73, v81
    v_add_f32 v58, v74, v82
    v_add_f32 v59, v75, v83
    v_add_f32 v60, v76, v84
    v_add_f32 v61, v77, v85
    v_add_f32 v62, v78, v86
    v_add_f32 v63, v79, v87
    v_cvt_pk_bf16_f32 v64, v56, v57
    v_cvt_pk_bf16_f32 v65, v58, v59
    v_cvt_pk_bf16_f32 v66, v60, v61
    v_cvt_pk_bf16_f32 v67, v62, v63
    v_cmp_gt_u32 vcc, 48, v0
    s_nop 1
    v_cndmask_b32 v64, 0, v64, vcc
    v_cndmask_b32 v65, 0, v65, vcc
    v_cndmask_b32 v66, 0, v66, vcc
    v_cndmask_b32 v67, 0, v67, vcc
    s_mul_i32 s52, s26, 784
    s_add_u32 s52, s52, 18720
    s_add_u32 s32, s24, s52
    s_addc_u32 s33, s25, 0
    s_mov_b32 s34, 784
    s_mov_b32 s35, 0x20000
    v_add3_u32 v68, v64, v65, v66
    v_add_u32 v68, v68, v67
    s_nop 1
    v_add_u32_dpp v68, v68, v68 row_shr:1 row_mask:0xf bank_mask:0xf bound_ctrl:0
    s_nop 1
    v_add_u32_dpp v68, v68, v68 row_shr:2 row_mask:0xf bank_mask:0xf bound_ctrl:0
    s_nop 1
    v_add_u32_dpp v68, v68, v68 row_shr:4 row_mask:0xf bank_mask:0xf bound_ctrl:0
    s_nop 1
    v_add_u32_dpp v68, v68, v68 row_shr:8 row_mask:0xf bank_mask:0xf bound_ctrl:0
    s_nop 1
    v_add_u32_dpp v68, v68, v68 row_bcast:15 row_mask:0xa bank_mask:0xf
    s_nop 1
    v_add_u32_dpp v68, v68, v68 row_bcast:31 row_mask:0xc bank_mask:0xf
    s_mov_b32 s53, 131072
    s_waitcnt vmcnt(0)
L_pn48:
    v_readfirstlane_b32 s27, v70
    s_cmp_lg_u32 s27, 0
    s_cbranch_scc1 L_pn48x
    buffer_load_dword v70, v71, s[40:43], 0 offen sc1
    s_sub_u32 s53, s53, 1
    s_waitcnt vmcnt(0)
    s_cbranch_scc0 L_pn48
L_pn48x:
    v_readlane_b32 s52, v68, 63
    s_add_u32 s52, s52, s27
    v_writelane_b32 v65, s27, 48
    v_writelane_b32 v64, s52, 48
    s_nop 1
    buffer_store_dwordx4 v[64:67], v13, s[32:35], 0 offen sc1
L_p_end:
    s_endpgm
L_endw:
L_endv:
    s_waitcnt vmcnt(0)
L_end:
    s_endpgm
.section .rodata,"a"
.p2align 6
.amdhsa_kernel standalone__deep_cross_xdeepfm__recsys_kernel
  .amdhsa_next_free_vgpr 256
  .amdhsa_next_free_sgpr 102
  .amdhsa_accum_offset 256
  .amdhsa_group_segment_fixed_size 0
  .amdhsa_kernarg_size 88
  .amdhsa_user_sgpr_count 2
  .amdhsa_user_sgpr_kernarg_segment_ptr 1
  .amdhsa_system_sgpr_workgroup_id_x 1
.end_amdhsa_kernel
```
